```python
import torch

def _softmax(x, axis=-1):
    return torch.softmax(x, dim=axis)
def _gelu(x):
    return torch.nn.functional.gelu(x, approximate="tanh")
def _silu(x):
    return torch.nn.functional.silu(x)
def _sigmoid(x):
    return torch.sigmoid(x)
def _layernorm(x, axis=-1, eps=1e-5):
    m = x.mean(dim=axis, keepdim=True)
    v = x.var(dim=axis, keepdim=True, unbiased=False)
    return (x - m) / torch.sqrt(v + eps)
def _scatter_add(tgt, idx, src, axis=0):
    return tgt.clone().index_add_(axis, idx, src)
def _segment_sum(src, seg, n):
    out = torch.zeros((n,) + src.shape[1:], dtype=src.dtype)
    return out.index_add_(0, seg, src)
def _pad(x, pw):
    flat = tuple(v for pair in reversed(pw) for v in pair)
    return torch.nn.functional.pad(x, flat)

kernel_name = 'parallel_sum__ssm_conv_h3__glu_gated_geglu__prompt'

def setup_inputs():

    _w = (lambda a: (lambda t: t.to(torch.bfloat16) if t.is_floating_point() else t)(torch.as_tensor(a)))
    def _A_setup():
        B, S, D = 1, 2048, 512
        ks = 4
        return {
            "q": _w((lambda *s: torch.randn(*s, dtype=torch.bfloat16) * 0.05)(B, S, D)),
            "k": _w((lambda *s: torch.randn(*s, dtype=torch.bfloat16) * 0.2)(B, S, D)),
            "v": _w((lambda *s: torch.randn(*s, dtype=torch.bfloat16) * 0.2)(B, S, D)),
            "shift_k": _w((lambda *s: torch.randn(*s, dtype=torch.bfloat16) * 0.2)(D, ks) * 0.5),
            "ssm_k": _w((lambda *s: torch.randn(*s, dtype=torch.bfloat16) * 0.4)(D, S) * (1.0 / S ** 0.5)),
            "ssm_D": _w((lambda *s: torch.randn(*s, dtype=torch.bfloat16) * 0.2)(D)),
        }
    _A_in = _A_setup()

    def _B_setup():
        B, S, Dm, Df = 1, 2048, 512, 1792
        return {
            "x": _w((lambda *s: torch.randn(*s, dtype=torch.bfloat16) * 0.05)(B, S, Dm)),
            "w_gate": _w((lambda *s: torch.randn(*s, dtype=torch.bfloat16) * 0.4)(Dm, Df) * (Dm ** -0.5)),
            "w_up": _w((lambda *s: torch.randn(*s, dtype=torch.bfloat16) * 0.4)(Dm, Df) * (Dm ** -0.5)),
            "w_down": _w((lambda *s: torch.randn(*s, dtype=torch.bfloat16) * 0.4)(Df, Dm) * (Df ** -0.5)),
        }
    _B_in = _B_setup()

    return {
        "A_q": _A_in["q"],
        "A_k": _A_in["k"],
        "A_v": _A_in["v"],
        "A_shift_k": _A_in["shift_k"],
        "A_ssm_k": _A_in["ssm_k"],
        "A_ssm_D": _A_in["ssm_D"],
        "B_x": _B_in["x"],
        "B_w_gate": _B_in["w_gate"],
        "B_w_up": _B_in["w_up"],
        "B_w_down": _B_in["w_down"],
    }

def reference(A_q, A_k, A_v, A_shift_k, A_ssm_k, A_ssm_D, B_x, B_w_gate, B_w_up, B_w_down):
    def _A_ref(q, k, v, shift_k, ssm_k, ssm_D):
        B, S, D = q.shape
        ks = shift_k.shape[-1]
        k_pad = _pad(k, ((0, 0), (ks - 1, 0), (0, 0)))
        k_shift = torch.zeros_like(k)
        for t in range(ks):
            k_shift = k_shift + k_pad[:, t:t + S, :] * shift_k[:, ks - 1 - t][None, None, :]
        kv = k_shift * v
        L = 2 * S
        kv_pad = _pad(kv, ((0, 0), (0, S), (0, 0)))
        kf_pad = _pad(ssm_k, ((0, 0), (0, S)))
        kv_f = (lambda x, axes=(-2,-1): torch.fft.rfft2(x.float(), dim=axes))(kv_pad[:, None, :, :], axes=(1, 2))
        kf_f = (lambda x, axes=(-2,-1): torch.fft.rfft2(x.float(), dim=axes))(kf_pad[:, None, :], axes=(1, 2))
        kf_f = (lambda x, *d: x.permute(*d))(kf_f, 1, 2, 0)
        y_f = kv_f * kf_f[None, :, :, :]
        y = (lambda x, s, axes=(-2,-1): torch.fft.irfft2(x, s=s, dim=axes).to(torch.bfloat16))(y_f, (1, L), axes=(1, 2))[:, 0, :S, :]
        y = y + kv * ssm_D[None, None, :]
        return q * y

    def _B_ref(x, w_gate, w_up, w_down):
        g = torch.einsum("bsd,df->bsf", x, w_gate)
        u = torch.einsum("bsd,df->bsf", x, w_up)
        h = _gelu(g) * u
        return torch.einsum("bsf,fd->bsd", h, w_down)

    x = A_q
    xn = _layernorm(x, axis=-1)
    return x + _A_ref(xn, A_k, A_v, A_shift_k, A_ssm_k, A_ssm_D) + _B_ref(xn, B_w_gate, B_w_up, B_w_down)
```

```asm
; @launch grid=(256,1,1) block=(512,1,1) lds=163840
.amdgcn_target "amdgcn-amd-amdhsa--gfx950"
.text
.globl parallel_sum__ssm_conv_h3__glu_gated_geglu__prompt_kernel
.p2align 8
.type parallel_sum__ssm_conv_h3__glu_gated_geglu__prompt_kernel,@function
parallel_sum__ssm_conv_h3__glu_gated_geglu__prompt_kernel:
    s_load_dwordx16 s[4:19], s[0:1], 0
    s_load_dwordx8 s[20:27], s[0:1], 64
    s_load_dwordx2 s[28:29], s[0:1], 96
    s_cmp_ge_u32 s2, 256
    s_cbranch_scc1 L_END
    v_lshrrev_b32 v1, 6, v0
    v_and_b32 v0, 63, v0
    v_readfirstlane_b32 s30, v1
    s_and_b32 s31, s2, 7
    s_lshr_b32 s32, s2, 3
    s_cmp_lg_u32 s30, 0
    s_cbranch_scc1 L_NOPF
    s_getpc_b64 s[60:61]
L_PC:
    v_lshlrev_b32 v1, 5, v0
    v_add_u32 v1, s32, v1
    v_lshlrev_b32 v1, 7, v1
    v_cmp_gt_u32 vcc, L_END-L_PC, v1
    s_nop 0
    s_and_saveexec_b64 s[62:63], vcc
    s_cbranch_execz L_PFX
    global_load_dword v39, v1, s[60:61]
L_PFX:
    s_mov_b64 exec, s[62:63]
L_NOPF:
    s_and_b32 s39, s32, 3
    s_lshr_b32 s38, s32, 2
    s_lshl_b32 s37, s31, 2
    s_add_u32 s37, s37, s39
    s_and_b32 s60, s31, 4
    s_and_b32 s61, s31, 3
    s_add_u32 s34, s60, s39
    s_mul_i32 s35, s61, 7
    s_add_u32 s35, s35, s38
    s_lshl_b32 s36, s61, 1
    s_add_u32 s36, s36, s60
    s_mov_b32 s33, s39
    s_and_b32 s36, s36, 7
    s_mov_b32 s3, s37
    s_lshr_b32 s37, s31, 1
    s_lshl_b32 s37, s37, 3
    s_and_b32 s60, s32, 7
    s_add_u32 s37, s37, s60
    s_and_b32 s60, s31, 1
    s_lshr_b32 s38, s32, 3
    s_lshl_b32 s38, s38, 1
    s_add_u32 s38, s38, s60
    s_sub_u32 s77, s30, 4
    s_cmp_ge_u32 s32, 28
    s_cbranch_scc1 L_SPARE
    s_cmp_lt_u32 s30, 4
    s_cbranch_scc1 L_MFMA
    s_and_b32 s62, s77, 1
    s_lshr_b32 s63, s77, 1
    v_lshrrev_b32 v1, 3, v0
    v_lshrrev_b32 v2, 4, v0
    v_and_b32 v3, 7, v0
    s_lshl_b32 s60, s62, 2
    v_add_u32 v4, s60, v2
    v_xor_b32 v4, v4, v3
    v_lshlrev_b32 v4, 4, v4
    v_lshl_add_u32 v13, v1, 10, v4
    v_and_b32 v2, 1, v2
    v_lshlrev_b32 v2, 1, v2
    s_lshl_b32 s60, s63, 2
    v_add_u32 v2, s60, v2
    v_xor_b32 v2, v2, v3
    v_lshlrev_b32 v2, 4, v2
    v_mul_u32_u24 v1, 3584, v1
    v_add_u32 v14, v1, v2
    s_lshl_b32 s64, s34, 18
    s_lshl_b32 s60, s77, 13
    s_add_u32 s64, s64, s60
    s_mul_i32 s65, s63, 28672
    s_lshl_b32 s60, s35, 7
    s_add_u32 s65, s65, s60
    s_lshl_b32 s66, s77, 10
    s_lshl_b32 s67, s62, 13
    s_lshl_b32 s60, s63, 10
    s_add_u32 s67, s67, s60
    s_add_u32 s67, s67, 32768
    s_mov_b32 s50, 1835008
    s_mov_b32 s51, 0x20000
    s_waitcnt lgkmcnt(0)
    s_mov_b32 s44, s4
    s_mov_b32 s45, s5
    s_mov_b32 s46, 2097152
    s_mov_b32 s47, 0x20000
    s_mov_b32 s40, s28
    s_mov_b32 s41, s29
    s_mov_b32 s42, 15728640
    s_mov_b32 s43, 0x20000
    s_cmp_eq_u32 s62, 0
    s_cselect_b32 s48, s18, s20
    s_cselect_b32 s49, s19, s21
    s_add_u32 s60, s36, 0
    s_and_b32 s60, s60, 7
    s_lshl_b32 s68, s60, 7
    s_add_u32 s68, s68, s64
    s_mul_i32 s69, s60, 229376
    s_add_u32 s69, s69, s65
    s_add_u32 m0, s67, 65536
    s_nop 0
    buffer_load_dwordx4 v14, s[48:51], s69 offen  lds
    s_add_u32 m0, s66, 65536
    s_add_u32 s69, s69, 57344
    buffer_load_dwordx4 v13, s[44:47], s68 offen  lds
    s_add_u32 m0, s66, 69632
    s_add_u32 s68, s68, 32768
    buffer_load_dwordx4 v13, s[44:47], s68 offen  lds
    s_add_u32 m0, s67, 67584
    s_add_u32 s68, s68, 32768
    buffer_load_dwordx4 v14, s[48:51], s69 offen  lds
    s_add_u32 m0, s66, 73728
    s_add_u32 s69, s69, 57344
    buffer_load_dwordx4 v13, s[44:47], s68 offen  lds
    s_add_u32 m0, s66, 77824
    s_add_u32 s68, s68, 32768
    buffer_load_dwordx4 v13, s[44:47], s68 offen  lds
    s_add_u32 m0, s67, 69632
    s_add_u32 s68, s68, 32768
    buffer_load_dwordx4 v14, s[48:51], s69 offen  lds
    s_add_u32 m0, s66, 81920
    s_add_u32 s69, s69, 57344
    buffer_load_dwordx4 v13, s[44:47], s68 offen  lds
    s_add_u32 m0, s66, 86016
    s_add_u32 s68, s68, 32768
    buffer_load_dwordx4 v13, s[44:47], s68 offen  lds
    s_add_u32 m0, s67, 71680
    s_add_u32 s68, s68, 32768
    buffer_load_dwordx4 v14, s[48:51], s69 offen  lds
    s_add_u32 m0, s66, 90112
    s_add_u32 s69, s69, 57344
    buffer_load_dwordx4 v13, s[44:47], s68 offen  lds
    s_add_u32 m0, s66, 94208
    s_add_u32 s68, s68, 32768
    buffer_load_dwordx4 v13, s[44:47], s68 offen  lds
    s_mov_b32 s56, s26
    s_mov_b32 s57, s27
    s_mov_b32 s58, 256
    s_mov_b32 s59, 0x20000
    v_lshrrev_b32 v2, 4, v0
    v_bfe_u32 v3, v0, 2, 2
    v_and_b32 v4, 2, v3
    v_and_b32 v5, 1, v2
    v_lshl_add_u32 v4, v5, 2, v4
    v_bfe_u32 v5, v0, 1, 1
    v_add_u32 v4, v4, v5
    v_lshlrev_b32 v4, 4, v4
    v_and_b32 v5, 1, v0
    v_lshl_add_u32 v4, v5, 3, v4
    v_lshl_add_u32 v3, v2, 3, v3
    v_lshl_add_u32 v15, v3, 7, v4
    s_lshl_b32 s60, s77, 5
    v_xor_b32 v15, s60, v15
    v_add_u32 v15, 32768, v15
    v_mov_b32 v48, 0x3f803f80
    v_mov_b32 v49, 0x3f803f80
    v_mov_b32 v50, 0x3f803f80
    v_mov_b32 v51, 0x3f803f80
    v_mov_b32 v68, 0
    v_lshlrev_b32 v1, 2, v0
    ds_write_b32 v1, v68 offset:1152
    s_waitcnt lgkmcnt(0)
    s_mov_b32 s52, s22
    s_mov_b32 s53, s23
    s_mov_b32 s54, 1835008
    s_mov_b32 s55, 0x20000
    v_lshrrev_b32 v1, 3, v0
    v_and_b32 v2, 6, v1
    v_and_b32 v3, 7, v0
    v_xor_b32 v2, v2, v3
    v_lshlrev_b32 v2, 4, v2
    v_lshl_add_u32 v10, v1, 10, v2
    s_mul_i32 s78, s77, 458752
    s_lshl_b32 s60, s38, 7
    s_add_u32 s78, s78, s60
    s_mul_i32 s79, s77, 12288
    s_mul_i32 s74, s31, 7
    s_lshr_b32 s74, s74, 3
    s_lshl_b32 s74, s74, 2
    v_lshrrev_b32 v2, 2, v0
    v_and_b32 v3, 6, v2
    v_bfe_u32 v4, v0, 1, 1
    v_add_u32 v3, v3, v4
    v_lshlrev_b32 v3, 4, v3
    v_and_b32 v4, 1, v0
    v_lshl_add_u32 v3, v4, 3, v3
    v_lshl_add_u32 v3, v2, 7, v3
    s_add_u32 s60, s79, 65536
    v_add_u32 v11, s60, v3
    v_xor_b32 v12, 32, v11
    v_lshlrev_b32 v66, 7, v0
    v_lshlrev_b32 v60, 3, v0
    v_lshlrev_b32 v61, 2, v0
    s_add_u32 s73, s36, s33
    s_and_b32 s73, s73, 7
    s_lshl_b32 s61, s35, 3
    s_add_u32 s73, s73, s61
    s_lshl_b32 s73, s73, 10
    s_lshl_b32 s61, s77, 8
    s_add_u32 s73, s73, s61
    s_add_u32 s73, s73, 131072
    s_lshl_b32 s75, s31, 5
    s_add_u32 s75, s75, s32
    s_lshl_b32 s75, s75, 6
    s_add_u32 s75, s75, 65536
    s_lshl_b32 s76, s34, 11
    s_lshl_b32 s61, s77, 9
    s_add_u32 s76, s76, s61
    s_add_u32 s76, s76, 65536
    v_and_b32 v1, 31, v0
    v_lshrrev_b32 v2, 5, v0
    v_lshlrev_b32 v62, 3, v1
    v_lshl_add_u32 v62, v2, 12, v62
    s_lshl_b32 s3, s35, 13
    s_lshl_b32 s61, s77, 8
    s_add_u32 s3, s3, s61
    s_add_u32 s3, s3, 131072
    v_add_u32 v64, s61, v61
    v_mul_u32_u24 v63, 2304, v2
    v_lshl_add_u32 v63, v1, 3, v63
    s_add_u32 s61, s61, 1536
    v_add_u32 v63, s61, v63
    v_add_u32 v65, 1152, v63
    s_add_u32 s60, s36, 1
    s_and_b32 s60, s60, 7
    s_lshl_b32 s68, s60, 7
    s_add_u32 s68, s68, s64
    s_mul_i32 s69, s60, 229376
    s_add_u32 s69, s69, s65
    s_add_u32 m0, s67, 16384
    s_nop 0
    buffer_load_dwordx4 v14, s[48:51], s69 offen  lds
    s_add_u32 m0, s66, 16384
    s_add_u32 s69, s69, 57344
    buffer_load_dwordx4 v13, s[44:47], s68 offen  lds
    s_add_u32 m0, s66, 20480
    s_add_u32 s68, s68, 32768
    buffer_load_dwordx4 v13, s[44:47], s68 offen  lds
    s_add_u32 m0, s67, 18432
    s_add_u32 s68, s68, 32768
    buffer_load_dwordx4 v14, s[48:51], s69 offen  lds
    s_add_u32 m0, s66, 24576
    s_add_u32 s69, s69, 57344
    buffer_load_dwordx4 v13, s[44:47], s68 offen  lds
    s_add_u32 m0, s66, 28672
    s_add_u32 s68, s68, 32768
    buffer_load_dwordx4 v13, s[44:47], s68 offen  lds
    s_add_u32 m0, s67, 20480
    s_add_u32 s68, s68, 32768
    buffer_load_dwordx4 v14, s[48:51], s69 offen  lds
    s_add_u32 m0, s66, 32768
    s_add_u32 s69, s69, 57344
    buffer_load_dwordx4 v13, s[44:47], s68 offen  lds
    s_add_u32 m0, s66, 36864
    s_add_u32 s68, s68, 32768
    buffer_load_dwordx4 v13, s[44:47], s68 offen  lds
    s_add_u32 m0, s67, 22528
    s_add_u32 s68, s68, 32768
    buffer_load_dwordx4 v14, s[48:51], s69 offen  lds
    s_add_u32 m0, s66, 40960
    s_add_u32 s69, s69, 57344
    buffer_load_dwordx4 v13, s[44:47], s68 offen  lds
    s_add_u32 m0, s66, 45056
    s_add_u32 s68, s68, 32768
    buffer_load_dwordx4 v13, s[44:47], s68 offen  lds
    s_waitcnt vmcnt(12)
    s_barrier
    s_cmp_lg_u32 s33, 0
    s_cbranch_scc1 NOCS_1
    v_add_u32 v9, 65536, v15
    ds_read_b64_tr_b16 v[32:33], v9 offset:0
    ds_read_b64_tr_b16 v[34:35], v9 offset:512
    ds_read_b64_tr_b16 v[36:37], v9 offset:4096
    ds_read_b64_tr_b16 v[38:39], v9 offset:4608
    ds_read_b64_tr_b16 v[40:41], v9 offset:8192
    ds_read_b64_tr_b16 v[42:43], v9 offset:8704
    ds_read_b64_tr_b16 v[44:45], v9 offset:12288
    ds_read_b64_tr_b16 v[46:47], v9 offset:12800
NOCS_1:
    s_add_u32 s60, s36, 2
    s_and_b32 s60, s60, 7
    s_lshl_b32 s68, s60, 7
    s_add_u32 s68, s68, s64
    s_mul_i32 s69, s60, 229376
    s_add_u32 s69, s69, s65
    s_add_u32 m0, s67, 114688
    s_nop 0
    buffer_load_dwordx4 v14, s[48:51], s69 offen  lds
    s_add_u32 m0, s66, 114688
    s_add_u32 s69, s69, 57344
    buffer_load_dwordx4 v13, s[44:47], s68 offen  lds
    s_add_u32 m0, s66, 118784
    s_add_u32 s68, s68, 32768
    buffer_load_dwordx4 v13, s[44:47], s68 offen  lds
    s_add_u32 m0, s67, 116736
    s_add_u32 s68, s68, 32768
    buffer_load_dwordx4 v14, s[48:51], s69 offen  lds
    s_add_u32 m0, s66, 122880
    s_add_u32 s69, s69, 57344
    buffer_load_dwordx4 v13, s[44:47], s68 offen  lds
    s_add_u32 m0, s66, 126976
    s_add_u32 s68, s68, 32768
    buffer_load_dwordx4 v13, s[44:47], s68 offen  lds
    s_add_u32 m0, s67, 118784
    s_add_u32 s68, s68, 32768
    buffer_load_dwordx4 v14, s[48:51], s69 offen  lds
    s_add_u32 m0, s66, 131072
    s_add_u32 s69, s69, 57344
    buffer_load_dwordx4 v13, s[44:47], s68 offen  lds
    s_add_u32 m0, s66, 135168
    s_add_u32 s68, s68, 32768
    buffer_load_dwordx4 v13, s[44:47], s68 offen  lds
    s_add_u32 m0, s67, 120832
    s_add_u32 s68, s68, 32768
    buffer_load_dwordx4 v14, s[48:51], s69 offen  lds
    s_add_u32 m0, s66, 139264
    s_add_u32 s69, s69, 57344
    buffer_load_dwordx4 v13, s[44:47], s68 offen  lds
    s_add_u32 m0, s66, 143360
    s_add_u32 s68, s68, 32768
    buffer_load_dwordx4 v13, s[44:47], s68 offen  lds
    s_cmp_lg_u32 s33, 0
    s_cbranch_scc1 NOCS_2
    s_waitcnt lgkmcnt(0)
    v_mfma_f32_16x16x32_bf16 v[16:19], v[48:51], v[32:35], 0
    v_mfma_f32_16x16x32_bf16 v[20:23], v[48:51], v[40:43], 0
    v_mfma_f32_16x16x32_bf16 v[16:19], v[48:51], v[36:39], v[16:19]
    v_mfma_f32_16x16x32_bf16 v[20:23], v[48:51], v[44:47], v[20:23]
NOCS_2:
    s_waitcnt vmcnt(12)
    s_barrier
    v_mov_b32 v9, 0
    buffer_load_dwordx2 v[54:55], v9, s[56:59], 0 offen sc1
    ds_read_b32 v58, v61 offset:1408
    s_cmp_lg_u32 s33, 1
    s_cbranch_scc1 NOCS_3
    v_add_u32 v9, 16384, v15
    ds_read_b64_tr_b16 v[32:33], v9 offset:0
    ds_read_b64_tr_b16 v[34:35], v9 offset:512
    ds_read_b64_tr_b16 v[36:37], v9 offset:4096
    ds_read_b64_tr_b16 v[38:39], v9 offset:4608
    ds_read_b64_tr_b16 v[40:41], v9 offset:8192
    ds_read_b64_tr_b16 v[42:43], v9 offset:8704
    ds_read_b64_tr_b16 v[44:45], v9 offset:12288
    ds_read_b64_tr_b16 v[46:47], v9 offset:12800
NOCS_3:
    s_add_u32 s60, s36, 3
    s_and_b32 s60, s60, 7
    s_lshl_b32 s68, s60, 7
    s_add_u32 s68, s68, s64
    s_mul_i32 s69, s60, 229376
    s_add_u32 s69, s69, s65
    s_add_u32 m0, s67, 65536
    s_nop 0
    buffer_load_dwordx4 v14, s[48:51], s69 offen  lds
    s_add_u32 m0, s66, 65536
    s_add_u32 s69, s69, 57344
    buffer_load_dwordx4 v13, s[44:47], s68 offen  lds
    s_add_u32 m0, s66, 69632
    s_add_u32 s68, s68, 32768
    buffer_load_dwordx4 v13, s[44:47], s68 offen  lds
    s_add_u32 m0, s67, 67584
    s_add_u32 s68, s68, 32768
    buffer_load_dwordx4 v14, s[48:51], s69 offen  lds
    s_add_u32 m0, s66, 73728
    s_add_u32 s69, s69, 57344
    buffer_load_dwordx4 v13, s[44:47], s68 offen  lds
    s_add_u32 m0, s66, 77824
    s_add_u32 s68, s68, 32768
    buffer_load_dwordx4 v13, s[44:47], s68 offen  lds
    s_add_u32 m0, s67, 69632
    s_add_u32 s68, s68, 32768
    buffer_load_dwordx4 v14, s[48:51], s69 offen  lds
    s_add_u32 m0, s66, 81920
    s_add_u32 s69, s69, 57344
    buffer_load_dwordx4 v13, s[44:47], s68 offen  lds
    s_add_u32 m0, s66, 86016
    s_add_u32 s68, s68, 32768
    buffer_load_dwordx4 v13, s[44:47], s68 offen  lds
    s_add_u32 m0, s67, 71680
    s_add_u32 s68, s68, 32768
    buffer_load_dwordx4 v14, s[48:51], s69 offen  lds
    s_add_u32 m0, s66, 90112
    s_add_u32 s69, s69, 57344
    buffer_load_dwordx4 v13, s[44:47], s68 offen  lds
    s_add_u32 m0, s66, 94208
    s_add_u32 s68, s68, 32768
    buffer_load_dwordx4 v13, s[44:47], s68 offen  lds
    s_cmp_lg_u32 s33, 1
    s_cbranch_scc1 NOCS_4
    s_waitcnt lgkmcnt(0)
    v_mfma_f32_16x16x32_bf16 v[16:19], v[48:51], v[32:35], 0
    v_mfma_f32_16x16x32_bf16 v[20:23], v[48:51], v[40:43], 0
    v_mfma_f32_16x16x32_bf16 v[16:19], v[48:51], v[36:39], v[16:19]
    v_mfma_f32_16x16x32_bf16 v[20:23], v[48:51], v[44:47], v[20:23]
NOCS_4:
    s_waitcnt vmcnt(13)
    s_barrier
    s_waitcnt lgkmcnt(0)
    s_cmp_lg_u32 s33, 2
    s_cbranch_scc1 NOCS_5
    v_add_u32 v9, 114688, v15
    ds_read_b64_tr_b16 v[32:33], v9 offset:0
    ds_read_b64_tr_b16 v[34:35], v9 offset:512
    ds_read_b64_tr_b16 v[36:37], v9 offset:4096
    ds_read_b64_tr_b16 v[38:39], v9 offset:4608
    ds_read_b64_tr_b16 v[40:41], v9 offset:8192
    ds_read_b64_tr_b16 v[42:43], v9 offset:8704
    ds_read_b64_tr_b16 v[44:45], v9 offset:12288
    ds_read_b64_tr_b16 v[46:47], v9 offset:12800
NOCS_5:
    s_add_u32 s60, s36, 4
    s_and_b32 s60, s60, 7
    s_lshl_b32 s68, s60, 7
    s_add_u32 s68, s68, s64
    s_mul_i32 s69, s60, 229376
    s_add_u32 s69, s69, s65
    s_add_u32 m0, s67, 16384
    s_nop 0
    buffer_load_dwordx4 v14, s[48:51], s69 offen  lds
    s_add_u32 m0, s66, 16384
    s_add_u32 s69, s69, 57344
    buffer_load_dwordx4 v13, s[44:47], s68 offen  lds
    s_add_u32 m0, s66, 20480
    s_add_u32 s68, s68, 32768
    buffer_load_dwordx4 v13, s[44:47], s68 offen  lds
    s_add_u32 m0, s67, 18432
    s_add_u32 s68, s68, 32768
    buffer_load_dwordx4 v14, s[48:51], s69 offen  lds
    s_add_u32 m0, s66, 24576
    s_add_u32 s69, s69, 57344
    buffer_load_dwordx4 v13, s[44:47], s68 offen  lds
    s_add_u32 m0, s66, 28672
    s_add_u32 s68, s68, 32768
    buffer_load_dwordx4 v13, s[44:47], s68 offen  lds
    s_add_u32 m0, s67, 20480
    s_add_u32 s68, s68, 32768
    buffer_load_dwordx4 v14, s[48:51], s69 offen  lds
    s_add_u32 m0, s66, 32768
    s_add_u32 s69, s69, 57344
    buffer_load_dwordx4 v13, s[44:47], s68 offen  lds
    s_add_u32 m0, s66, 36864
    s_add_u32 s68, s68, 32768
    buffer_load_dwordx4 v13, s[44:47], s68 offen  lds
    s_add_u32 m0, s67, 22528
    s_add_u32 s68, s68, 32768
    buffer_load_dwordx4 v14, s[48:51], s69 offen  lds
    s_add_u32 m0, s66, 40960
    s_add_u32 s69, s69, 57344
    buffer_load_dwordx4 v13, s[44:47], s68 offen  lds
    s_add_u32 m0, s66, 45056
    s_add_u32 s68, s68, 32768
    buffer_load_dwordx4 v13, s[44:47], s68 offen  lds
    s_cmp_lg_u32 s33, 2
    s_cbranch_scc1 NOCS_6
    s_waitcnt lgkmcnt(0)
    v_mfma_f32_16x16x32_bf16 v[16:19], v[48:51], v[32:35], 0
    v_mfma_f32_16x16x32_bf16 v[20:23], v[48:51], v[40:43], 0
    v_mfma_f32_16x16x32_bf16 v[16:19], v[48:51], v[36:39], v[16:19]
    v_mfma_f32_16x16x32_bf16 v[20:23], v[48:51], v[44:47], v[20:23]
NOCS_6:
    s_waitcnt vmcnt(12)
    s_barrier
    s_cmp_lg_u32 s33, 3
    s_cbranch_scc1 NOCS_7
    v_add_u32 v9, 65536, v15
    ds_read_b64_tr_b16 v[32:33], v9 offset:0
    ds_read_b64_tr_b16 v[34:35], v9 offset:512
    ds_read_b64_tr_b16 v[36:37], v9 offset:4096
    ds_read_b64_tr_b16 v[38:39], v9 offset:4608
    ds_read_b64_tr_b16 v[40:41], v9 offset:8192
    ds_read_b64_tr_b16 v[42:43], v9 offset:8704
    ds_read_b64_tr_b16 v[44:45], v9 offset:12288
    ds_read_b64_tr_b16 v[46:47], v9 offset:12800
NOCS_7:
    s_add_u32 s60, s36, 5
    s_and_b32 s60, s60, 7
    s_lshl_b32 s68, s60, 7
    s_add_u32 s68, s68, s64
    s_mul_i32 s69, s60, 229376
    s_add_u32 s69, s69, s65
    s_add_u32 m0, s67, 114688
    s_nop 0
    buffer_load_dwordx4 v14, s[48:51], s69 offen  lds
    s_add_u32 m0, s66, 114688
    s_add_u32 s69, s69, 57344
    buffer_load_dwordx4 v13, s[44:47], s68 offen  lds
    s_add_u32 m0, s66, 118784
    s_add_u32 s68, s68, 32768
    buffer_load_dwordx4 v13, s[44:47], s68 offen  lds
    s_add_u32 m0, s67, 116736
    s_add_u32 s68, s68, 32768
    buffer_load_dwordx4 v14, s[48:51], s69 offen  lds
    s_add_u32 m0, s66, 122880
    s_add_u32 s69, s69, 57344
    buffer_load_dwordx4 v13, s[44:47], s68 offen  lds
    s_add_u32 m0, s66, 126976
    s_add_u32 s68, s68, 32768
    buffer_load_dwordx4 v13, s[44:47], s68 offen  lds
    s_add_u32 m0, s67, 118784
    s_add_u32 s68, s68, 32768
    buffer_load_dwordx4 v14, s[48:51], s69 offen  lds
    s_add_u32 m0, s66, 131072
    s_add_u32 s69, s69, 57344
    buffer_load_dwordx4 v13, s[44:47], s68 offen  lds
    s_add_u32 m0, s66, 135168
    s_add_u32 s68, s68, 32768
    buffer_load_dwordx4 v13, s[44:47], s68 offen  lds
    s_add_u32 m0, s67, 120832
    s_add_u32 s68, s68, 32768
    buffer_load_dwordx4 v14, s[48:51], s69 offen  lds
    s_add_u32 m0, s66, 139264
    s_add_u32 s69, s69, 57344
    buffer_load_dwordx4 v13, s[44:47], s68 offen  lds
    s_add_u32 m0, s66, 143360
    s_add_u32 s68, s68, 32768
    buffer_load_dwordx4 v13, s[44:47], s68 offen  lds
    s_cmp_lg_u32 s33, 3
    s_cbranch_scc1 NOCS_8
    s_waitcnt lgkmcnt(0)
    v_mfma_f32_16x16x32_bf16 v[16:19], v[48:51], v[32:35], 0
    v_mfma_f32_16x16x32_bf16 v[20:23], v[48:51], v[40:43], 0
    v_mfma_f32_16x16x32_bf16 v[16:19], v[48:51], v[36:39], v[16:19]
    v_mfma_f32_16x16x32_bf16 v[20:23], v[48:51], v[44:47], v[20:23]
NOCS_8:
    v_readfirstlane_b32 s70, v54
    v_readfirstlane_b32 s71, v55
    s_nop 0
    s_cmp_lg_u32 s71, 0
    s_cbranch_scc1 L_HAVEN
    s_mov_b32 s72, 100000
    v_mov_b32 v56, 0
NON_9:
    buffer_load_dwordx2 v[54:55], v56, s[56:59], 0 offen sc1
    s_waitcnt vmcnt(0)
    v_readfirstlane_b32 s70, v54
    v_readfirstlane_b32 s71, v55
    s_nop 0
    s_cmp_lg_u32 s71, 0
    s_cbranch_scc1 NOND_10
    s_sleep 4
    s_sub_u32 s72, s72, 1
    s_cmp_lg_u32 s72, 0
    s_cbranch_scc1 NON_9
NOND_10:
    s_xor_b32 s71, s70, 1540483477
L_HAVEN:
    s_xor_b32 s71, s70, 1540483477
    v_mov_b32 v53, s70
    v_mov_b32 v59, s70
    s_cmp_eq_u32 s77, 0
    s_cselect_b32 exec_lo, 0xff, 0
    s_mov_b32 exec_hi, 0
    buffer_store_dwordx2 v[58:59], v60, s[40:43], s75 offen sc1
    s_mov_b64 exec, -1
    v_cmp_gt_u32 vcc, 16, v0
    s_nop 7
    v_cndmask_b32 v16, v20, v16, vcc
    v_cvt_pk_bf16_f32 v17, v16, v16
    v_lshlrev_b32 v17, 16, v17
    v_sub_f32 v17, v16, v17
    v_cvt_pk_bf16_f32 v52, v16, v17
    ds_write_b32 v68, v53 offset:1024
    s_mov_b32 exec_hi, 0
    buffer_store_dwordx2 v[52:53], v60, s[40:43], s73 offen sc1
    s_mov_b64 exec, -1
    s_waitcnt vmcnt(14)
    s_barrier
    s_lshr_b32 s73, s32, 3
    s_mul_i32 s73, s73, 0
    s_add_u32 s73, s73, s74
    s_sub_u32 s60, s73, 28
    s_cmp_ge_u32 s73, 28
    s_cselect_b32 s73, s60, s73
    s_add_u32 s60, s36, 6
    s_and_b32 s60, s60, 7
    s_lshl_b32 s68, s60, 7
    s_add_u32 s68, s68, s64
    s_mul_i32 s69, s60, 229376
    s_add_u32 s69, s69, s65
    s_add_u32 m0, s67, 65536
    s_nop 0
    buffer_load_dwordx4 v14, s[48:51], s69 offen  lds
    s_add_u32 m0, s66, 65536
    s_add_u32 s69, s69, 57344
    buffer_load_dwordx4 v13, s[44:47], s68 offen  lds
    s_add_u32 m0, s66, 69632
    s_add_u32 s68, s68, 32768
    buffer_load_dwordx4 v13, s[44:47], s68 offen  lds
    s_add_u32 m0, s67, 67584
    s_add_u32 s68, s68, 32768
    buffer_load_dwordx4 v14, s[48:51], s69 offen  lds
    s_add_u32 m0, s66, 73728
    s_add_u32 s69, s69, 57344
    buffer_load_dwordx4 v13, s[44:47], s68 offen  lds
    s_add_u32 m0, s66, 77824
    s_add_u32 s68, s68, 32768
    buffer_load_dwordx4 v13, s[44:47], s68 offen  lds
    s_add_u32 m0, s67, 69632
    s_add_u32 s68, s68, 32768
    buffer_load_dwordx4 v14, s[48:51], s69 offen  lds
    s_add_u32 m0, s66, 81920
    s_add_u32 s69, s69, 57344
    buffer_load_dwordx4 v13, s[44:47], s68 offen  lds
    s_add_u32 m0, s66, 86016
    s_add_u32 s68, s68, 32768
    buffer_load_dwordx4 v13, s[44:47], s68 offen  lds
    s_add_u32 m0, s67, 71680
    s_add_u32 s68, s68, 32768
    buffer_load_dwordx4 v14, s[48:51], s69 offen  lds
    s_add_u32 m0, s66, 90112
    s_add_u32 s69, s69, 57344
    buffer_load_dwordx4 v13, s[44:47], s68 offen  lds
    s_add_u32 m0, s66, 94208
    s_add_u32 s68, s68, 32768
    buffer_load_dwordx4 v13, s[44:47], s68 offen  lds
    s_waitcnt vmcnt(14)
    s_barrier
    s_add_u32 s60, s36, 7
    s_and_b32 s60, s60, 7
    s_lshl_b32 s68, s60, 7
    s_add_u32 s68, s68, s64
    s_mul_i32 s69, s60, 229376
    s_add_u32 s69, s69, s65
    s_add_u32 m0, s67, 16384
    s_nop 0
    buffer_load_dwordx4 v14, s[48:51], s69 offen  lds
    s_add_u32 m0, s66, 16384
    s_add_u32 s69, s69, 57344
    buffer_load_dwordx4 v13, s[44:47], s68 offen  lds
    s_add_u32 m0, s66, 20480
    s_add_u32 s68, s68, 32768
    buffer_load_dwordx4 v13, s[44:47], s68 offen  lds
    s_add_u32 m0, s67, 18432
    s_add_u32 s68, s68, 32768
    buffer_load_dwordx4 v14, s[48:51], s69 offen  lds
    s_add_u32 m0, s66, 24576
    s_add_u32 s69, s69, 57344
    buffer_load_dwordx4 v13, s[44:47], s68 offen  lds
    s_add_u32 m0, s66, 28672
    s_add_u32 s68, s68, 32768
    buffer_load_dwordx4 v13, s[44:47], s68 offen  lds
    s_add_u32 m0, s67, 20480
    s_add_u32 s68, s68, 32768
    buffer_load_dwordx4 v14, s[48:51], s69 offen  lds
    s_add_u32 m0, s66, 32768
    s_add_u32 s69, s69, 57344
    buffer_load_dwordx4 v13, s[44:47], s68 offen  lds
    s_add_u32 m0, s66, 36864
    s_add_u32 s68, s68, 32768
    buffer_load_dwordx4 v13, s[44:47], s68 offen  lds
    s_add_u32 m0, s67, 22528
    s_add_u32 s68, s68, 32768
    buffer_load_dwordx4 v14, s[48:51], s69 offen  lds
    s_add_u32 m0, s66, 40960
    s_add_u32 s69, s69, 57344
    buffer_load_dwordx4 v13, s[44:47], s68 offen  lds
    s_add_u32 m0, s66, 45056
    s_add_u32 s68, s68, 32768
    buffer_load_dwordx4 v13, s[44:47], s68 offen  lds
    s_mov_b32 s56, s12
    s_mov_b32 s57, s13
    s_mov_b32 s58, 2097152
    s_mov_b32 s59, 0x20000
    v_lshlrev_b32 v75, 4, v0
    s_bfe_u32 s62, s30, 0x10001
    s_and_b32 s63, s30, 1
    s_mul_i32 s62, s62, 4160
    s_mul_i32 s61, s63, 4128
    s_add_u32 s61, s61, s62
    v_lshrrev_b32 v70, 2, v75
    v_add_u32 v70, s61, v70
    s_mov_b64 exec, 0xff
    ds_write_b32 v70, v68 offset:6144
    s_mov_b64 exec, -1
    s_lshl_b32 s63, s63, 11
    s_add_u32 s62, s62, s63
    s_add_u32 m0, s62, 6176
    s_and_b32 s61, s30, 3
    s_lshl_b32 s61, s61, 11
    s_lshl_b32 s60, s2, 13
    s_add_u32 s60, s60, s61
    buffer_load_dwordx4 v75, s[56:59], s60 offen offset:0 lds
    buffer_load_dwordx4 v75, s[56:59], s60 offen offset:1024 lds
    buffer_load_dwordx2 v[16:17], v60, s[40:43], s76 offen sc1
    buffer_load_dwordx2 v[18:19], v62, s[40:43], s3 offen offset:0 sc1
    buffer_load_dwordx2 v[20:21], v62, s[40:43], s3 offen offset:1024 sc1
    buffer_load_dwordx2 v[22:23], v62, s[40:43], s3 offen offset:2048 sc1
    buffer_load_dwordx2 v[24:25], v62, s[40:43], s3 offen offset:3072 sc1
    s_waitcnt vmcnt(19)
    s_barrier
    s_add_u32 s60, s74, 0
    s_lshl_b32 s60, s60, 14
    s_add_u32 s60, s60, s78
    s_add_u32 m0, s79, 114688
    s_add_u32 s61, s60, 8192
    buffer_load_dwordx4 v10, s[52:55], s60 offen lds
    s_add_u32 m0, s79, 115712
    s_nop 0
    buffer_load_dwordx4 v10, s[52:55], s61 offen lds
    s_add_u32 s60, s74, 1
    s_lshl_b32 s60, s60, 14
    s_add_u32 s60, s60, s78
    s_add_u32 m0, s79, 116736
    s_add_u32 s61, s60, 8192
    buffer_load_dwordx4 v10, s[52:55], s60 offen lds
    s_add_u32 m0, s79, 117760
    s_nop 0
    buffer_load_dwordx4 v10, s[52:55], s61 offen lds
    s_waitcnt vmcnt(11)
    v_mov_b32 v69, 1
    s_mov_b64 exec, 1
    ds_add_u32 v68, v69 offset:1164
    s_mov_b64 exec, -1
    s_add_u32 s60, s73, 2
    s_lshl_b32 s60, s60, 14
    s_add_u32 s60, s60, s78
    s_add_u32 m0, s79, 118784
    s_add_u32 s61, s60, 8192
    buffer_load_dwordx4 v10, s[52:55], s60 offen lds
    s_add_u32 m0, s79, 119808
    s_nop 0
    buffer_load_dwordx4 v10, s[52:55], s61 offen lds
    s_add_u32 s60, s73, 3
    s_lshl_b32 s60, s60, 14
    s_add_u32 s60, s60, s78
    s_add_u32 m0, s79, 120832
    s_add_u32 s61, s60, 8192
    buffer_load_dwordx4 v10, s[52:55], s60 offen lds
    s_add_u32 m0, s79, 121856
    s_nop 0
    buffer_load_dwordx4 v10, s[52:55], s61 offen lds
    s_waitcnt vmcnt(8)
    s_mov_b32 s72, 100000
GR_11:
    v_cmp_ne_u32 vcc, s70, v17
    v_cmp_ne_u32 s[60:61], s70, v19
    s_nop 0
    s_or_b64 vcc, vcc, s[60:61]
    v_cmp_ne_u32 s[60:61], s70, v21
    s_nop 0
    s_or_b64 vcc, vcc, s[60:61]
    v_cmp_ne_u32 s[60:61], s70, v23
    s_nop 0
    s_or_b64 vcc, vcc, s[60:61]
    v_cmp_ne_u32 s[60:61], s70, v25
    s_nop 0
    s_or_b64 vcc, vcc, s[60:61]
    s_cbranch_scc0 GRD_12
    s_sleep 4
    buffer_load_dwordx2 v[16:17], v60, s[40:43], s76 offen sc1
    buffer_load_dwordx2 v[18:19], v62, s[40:43], s3 offen offset:0 sc1
    buffer_load_dwordx2 v[20:21], v62, s[40:43], s3 offen offset:1024 sc1
    buffer_load_dwordx2 v[22:23], v62, s[40:43], s3 offen offset:2048 sc1
    buffer_load_dwordx2 v[24:25], v62, s[40:43], s3 offen offset:3072 sc1
    s_waitcnt vmcnt(0)
    s_sub_u32 s72, s72, 1
    s_cmp_lg_u32 s72, 0
    s_cbranch_scc1 GR_11
GRD_12:
    ds_write2_b32 v63, v18, v20 offset0:0 offset1:1
    ds_write2_b32 v65, v22, v24 offset0:0 offset1:1
    ds_write_b32 v64, v16 offset:0
    v_mov_b32 v69, 1
    s_mov_b64 exec, 1
    ds_add_u32 v68, v69 offset:1180
    s_mov_b64 exec, -1
    s_add_u32 s60, s74, 4
    s_sub_u32 s61, s60, 28
    s_cmp_ge_u32 s60, 28
    s_cselect_b32 s60, s61, s60
    s_lshl_b32 s60, s60, 14
    s_add_u32 s60, s60, s78
    s_add_u32 m0, s79, 122880
    s_add_u32 s61, s60, 8192
    buffer_load_dwordx4 v10, s[52:55], s60 offen lds
    s_add_u32 m0, s79, 123904
    s_nop 0
    buffer_load_dwordx4 v10, s[52:55], s61 offen lds
    s_add_u32 s60, s74, 5
    s_sub_u32 s61, s60, 28
    s_cmp_ge_u32 s60, 28
    s_cselect_b32 s60, s61, s60
    s_lshl_b32 s60, s60, 14
    s_add_u32 s60, s60, s78
    s_add_u32 m0, s79, 124928
    s_add_u32 s61, s60, 8192
    buffer_load_dwordx4 v10, s[52:55], s60 offen lds
    s_add_u32 m0, s79, 125952
    s_nop 0
    buffer_load_dwordx4 v10, s[52:55], s61 offen lds
    s_mov_b32 s72, 800000
SB_13:
    s_sleep 1
    ds_read_b32 v69, v68 offset:1168
    s_sub_u32 s72, s72, 1
    s_waitcnt lgkmcnt(0)
    v_readfirstlane_b32 s60, v69
    s_cmp_eq_u32 s72, 0
    s_cbranch_scc1 SB_13_D
    s_cmp_lt_u32 s60, 4
    s_cbranch_scc1 SB_13
SB_13_D:
    v_xor_b32 v13, 64, v11
    v_xor_b32 v14, 96, v11
    s_waitcnt vmcnt(10)
    ds_read_b64_tr_b16 v[80:81], v11 offset:49152
    ds_read_b64_tr_b16 v[84:85], v12 offset:49152
    ds_read_b64_tr_b16 v[88:89], v13 offset:49152
    ds_read_b64_tr_b16 v[92:93], v14 offset:49152
    s_add_u32 s60, s74, 8
    s_sub_u32 s61, s60, 28
    s_cmp_ge_u32 s60, 28
    s_cselect_b32 s60, s61, s60
    s_lshl_b32 s60, s60, 14
    s_add_u32 s60, s60, s78
    s_add_u32 m0, s79, 65536
    s_add_u32 s61, s60, 8192
    buffer_load_dwordx4 v10, s[52:55], s60 offen lds
    s_add_u32 m0, s79, 66560
    s_nop 0
    buffer_load_dwordx4 v10, s[52:55], s61 offen lds
    v_and_b32 v74, 15, v0
    v_lshlrev_b32 v74, 7, v74
    s_lshr_b32 s75, s2, 5
    s_lshl_b32 s75, s75, 12
    s_and_b32 s60, s30, 1
    s_lshl_b32 s60, s60, 11
    s_sub_u32 s75, s75, s60
    s_add_u32 s75, s75, 395264
    buffer_load_dwordx2 v[72:73], v74, s[40:43], s75 offen sc1
    s_waitcnt vmcnt(11)
    ds_read_b64_tr_b16 v[82:83], v11 offset:51200
    ds_read_b64_tr_b16 v[86:87], v12 offset:51200
    ds_read_b64_tr_b16 v[90:91], v13 offset:51200
    ds_read_b64_tr_b16 v[94:95], v14 offset:51200
    s_add_u32 s60, s74, 9
    s_sub_u32 s61, s60, 28
    s_cmp_ge_u32 s60, 28
    s_cselect_b32 s60, s61, s60
    s_lshl_b32 s60, s60, 14
    s_add_u32 s60, s60, s78
    s_add_u32 m0, s79, 67584
    s_add_u32 s61, s60, 8192
    buffer_load_dwordx4 v10, s[52:55], s60 offen lds
    s_add_u32 m0, s79, 68608
    s_nop 0
    buffer_load_dwordx4 v10, s[52:55], s61 offen lds
    s_waitcnt vmcnt(11)
    ds_read_b64_tr_b16 v[192:193], v11 offset:53248
    ds_read_b64_tr_b16 v[196:197], v12 offset:53248
    ds_read_b64_tr_b16 v[200:201], v13 offset:53248
    ds_read_b64_tr_b16 v[204:205], v14 offset:53248
    s_waitcnt lgkmcnt(4)
    s_add_u32 s60, s74, 12
    s_sub_u32 s61, s60, 28
    s_cmp_ge_u32 s60, 28
    s_cselect_b32 s60, s61, s60
    s_lshl_b32 s60, s60, 14
    s_add_u32 s60, s60, s78
    s_add_u32 m0, s79, 69632
    s_add_u32 s61, s60, 8192
    buffer_load_dwordx4 v10, s[52:55], s60 offen lds
    s_add_u32 m0, s79, 70656
    s_nop 0
    buffer_load_dwordx4 v10, s[52:55], s61 offen lds
    s_waitcnt vmcnt(11)
    ds_read_b64_tr_b16 v[194:195], v11 offset:55296
    ds_read_b64_tr_b16 v[198:199], v12 offset:55296
    ds_read_b64_tr_b16 v[202:203], v13 offset:55296
    ds_read_b64_tr_b16 v[206:207], v14 offset:55296
    s_add_u32 s60, s74, 13
    s_sub_u32 s61, s60, 28
    s_cmp_ge_u32 s60, 28
    s_cselect_b32 s60, s61, s60
    s_lshl_b32 s60, s60, 14
    s_add_u32 s60, s60, s78
    s_add_u32 m0, s79, 71680
    s_add_u32 s61, s60, 8192
    buffer_load_dwordx4 v10, s[52:55], s60 offen lds
    s_add_u32 m0, s79, 72704
    s_nop 0
    buffer_load_dwordx4 v10, s[52:55], s61 offen lds
    s_waitcnt vmcnt(6)
    v_cmp_ne_u64 vcc, s[70:71], v[72:73]
    s_cbranch_vccz L_KVOK
    s_mov_b32 s72, 100000
POLL_14:
    buffer_load_dwordx2 v[72:73], v74, s[40:43], s75 offen sc1
    s_waitcnt vmcnt(0)
    v_cmp_ne_u64 vcc, s[70:71], v[72:73]
    s_cbranch_vccz POLLD_15
    s_sleep 8
    s_sub_u32 s72, s72, 1
    s_cmp_lg_u32 s72, 0
    s_cbranch_scc1 POLL_14
POLLD_15:
L_KVOK:
    s_and_b32 s61, s30, 3
    s_lshl_b32 s61, s61, 11
    s_lshl_b32 s60, s2, 13
    s_add_u32 s61, s60, s61
    s_add_u32 s61, s61, 1048576
    buffer_load_dwordx4 v[32:35], v75, s[40:43], s61 offen offset:0 sc1
    buffer_load_dwordx4 v[36:39], v75, s[40:43], s61 offen offset:1024 sc1
    s_waitcnt vmcnt(13)
    ds_read_b64_tr_b16 v[96:97], v11 offset:57344
    ds_read_b64_tr_b16 v[100:101], v12 offset:57344
    ds_read_b64_tr_b16 v[104:105], v13 offset:57344
    ds_read_b64_tr_b16 v[108:109], v14 offset:57344
    s_add_u32 s60, s74, 16
    s_sub_u32 s61, s60, 28
    s_cmp_ge_u32 s60, 28
    s_cselect_b32 s60, s61, s60
    s_lshl_b32 s60, s60, 14
    s_add_u32 s60, s60, s78
    s_add_u32 m0, s79, 73728
    s_add_u32 s61, s60, 8192
    buffer_load_dwordx4 v10, s[52:55], s60 offen lds
    s_add_u32 m0, s79, 74752
    s_nop 0
    buffer_load_dwordx4 v10, s[52:55], s61 offen lds
    s_waitcnt vmcnt(13)
    ds_read_b64_tr_b16 v[98:99], v11 offset:59392
    ds_read_b64_tr_b16 v[102:103], v12 offset:59392
    ds_read_b64_tr_b16 v[106:107], v13 offset:59392
    ds_read_b64_tr_b16 v[110:111], v14 offset:59392
    s_waitcnt lgkmcnt(4)
    s_add_u32 s60, s74, 17
    s_sub_u32 s61, s60, 28
    s_cmp_ge_u32 s60, 28
    s_cselect_b32 s60, s61, s60
    s_lshl_b32 s60, s60, 14
    s_add_u32 s60, s60, s78
    s_add_u32 m0, s79, 75776
    s_add_u32 s61, s60, 8192
    buffer_load_dwordx4 v10, s[52:55], s60 offen lds
    s_add_u32 m0, s79, 76800
    s_nop 0
    buffer_load_dwordx4 v10, s[52:55], s61 offen lds
    s_waitcnt vmcnt(13)
    ds_read_b64_tr_b16 v[112:113], v11 offset:0
    ds_read_b64_tr_b16 v[116:117], v12 offset:0
    ds_read_b64_tr_b16 v[120:121], v13 offset:0
    ds_read_b64_tr_b16 v[124:125], v14 offset:0
    s_waitcnt vmcnt(10)
    ds_read_b64_tr_b16 v[114:115], v11 offset:2048
    ds_read_b64_tr_b16 v[118:119], v12 offset:2048
    ds_read_b64_tr_b16 v[122:123], v13 offset:2048
    ds_read_b64_tr_b16 v[126:127], v14 offset:2048
    s_waitcnt vmcnt(8)
    ds_read_b64_tr_b16 v[128:129], v11 offset:4096
    ds_read_b64_tr_b16 v[132:133], v12 offset:4096
    ds_read_b64_tr_b16 v[136:137], v13 offset:4096
    ds_read_b64_tr_b16 v[140:141], v14 offset:4096
    s_waitcnt lgkmcnt(4)
    s_waitcnt lgkmcnt(0)
    s_add_u32 s60, s74, 20
    s_sub_u32 s61, s60, 28
    s_cmp_ge_u32 s60, 28
    s_cselect_b32 s60, s61, s60
    s_lshl_b32 s60, s60, 14
    s_add_u32 s60, s60, s78
    s_add_u32 m0, s79, 114688
    s_add_u32 s61, s60, 8192
    buffer_load_dwordx4 v10, s[52:55], s60 offen lds
    s_add_u32 m0, s79, 115712
    s_nop 0
    buffer_load_dwordx4 v10, s[52:55], s61 offen lds
    s_waitcnt vmcnt(8)
    ds_read_b64_tr_b16 v[130:131], v11 offset:6144
    ds_read_b64_tr_b16 v[134:135], v12 offset:6144
    ds_read_b64_tr_b16 v[138:139], v13 offset:6144
    ds_read_b64_tr_b16 v[142:143], v14 offset:6144
    s_waitcnt lgkmcnt(0)
    s_add_u32 s60, s74, 21
    s_sub_u32 s61, s60, 28
    s_cmp_ge_u32 s60, 28
    s_cselect_b32 s60, s61, s60
    s_lshl_b32 s60, s60, 14
    s_add_u32 s60, s60, s78
    s_add_u32 m0, s79, 116736
    s_add_u32 s61, s60, 8192
    buffer_load_dwordx4 v10, s[52:55], s60 offen lds
    s_add_u32 m0, s79, 117760
    s_nop 0
    buffer_load_dwordx4 v10, s[52:55], s61 offen lds
    s_mov_b32 s72, 800000
SB_16:
    s_sleep 1
    ds_read_b32 v69, v68 offset:1172
    s_sub_u32 s72, s72, 1
    s_waitcnt lgkmcnt(0)
    v_readfirstlane_b32 s60, v69
    s_cmp_eq_u32 s72, 0
    s_cbranch_scc1 SB_16_D
    s_cmp_lt_u32 s60, 4
    s_cbranch_scc1 SB_16
SB_16_D:
    s_mov_b32 s72, 800000
SB_17:
    ds_read_b32 v69, v68 offset:1180
    s_sub_u32 s72, s72, 1
    s_waitcnt lgkmcnt(0)
    v_readfirstlane_b32 s60, v69
    s_cmp_eq_u32 s72, 0
    s_cbranch_scc1 SB_17_D
    s_cmp_lt_u32 s60, 4
    s_cbranch_scc1 SB_17
SB_17_D:
    s_bfe_u32 s62, s30, 0x10001
    s_and_b32 s63, s30, 1
    s_mul_i32 s72, s62, 4608
    s_lshl_b32 s60, s63, 11
    s_mul_i32 s62, s62, 4160
    s_add_u32 s60, s60, s62
    v_lshl_add_u32 v26, v75, 1, s60
    ds_read_b128 v[16:19], v26 offset:6176
    ds_read_b128 v[20:23], v26 offset:6192
    ds_read_b32 v24, v26 offset:6208
    v_lshrrev_b32 v25, 2, v75
    s_lshl_b32 s60, s63, 8
    s_add_u32 s60, s60, s72
    v_add_u32 v27, s60, v25
    ds_write_b32 v27, v68 offset:59712
    v_add_u32 v25, s62, v25
    v_cmp_eq_u32 vcc, 7, v0
    s_waitcnt lgkmcnt(1)
    v_readfirstlane_b32 s60, v16
    v_alignbit_b32 v16, v17, v16, 16
    v_alignbit_b32 v17, v18, v17, 16
    v_alignbit_b32 v18, v19, v18, 16
    v_alignbit_b32 v19, v20, v19, 16
    v_alignbit_b32 v20, v21, v20, 16
    v_alignbit_b32 v21, v22, v21, 16
    v_alignbit_b32 v22, v23, v22, 16
    v_alignbit_b32 v23, v24, v23, 16
    s_lshl_b32 s60, s60, 16
    v_mov_b32 v24, s60
    ds_write_b128 v26, v[16:19] offset:47328
    ds_write_b128 v26, v[20:23] offset:47344
    v_cndmask_b32 v24, v68, v24, vcc
    s_cmp_eq_u32 s63, 0
    s_cselect_b32 exec_lo, 0xff, 0
    s_mov_b32 exec_hi, 0
    ds_write_b32 v25, v24 offset:47296
    s_mov_b64 exec, -1
    s_waitcnt vmcnt(8)
    s_bfe_u32 s62, s30, 0x10001
    s_and_b32 s63, s30, 1
    s_mul_i32 s62, s62, 4608
    s_lshl_b32 s63, s63, 11
    s_add_u32 s62, s62, s63
    v_add_u32 v16, s62, v75
    ds_write_b128 v16, v[32:35] offset:55616
    ds_write_b128 v16, v[36:39] offset:56640
    v_mov_b32 v69, 1
    s_mov_b64 exec, 1
    ds_add_u32 v68, v69 offset:1152
    s_mov_b64 exec, -1
    s_waitcnt vmcnt(6)
    ds_read_b64_tr_b16 v[144:145], v11 offset:8192
    ds_read_b64_tr_b16 v[148:149], v12 offset:8192
    ds_read_b64_tr_b16 v[152:153], v13 offset:8192
    ds_read_b64_tr_b16 v[156:157], v14 offset:8192
    s_waitcnt lgkmcnt(0)
    s_add_u32 s60, s74, 24
    s_sub_u32 s61, s60, 28
    s_cmp_ge_u32 s60, 28
    s_cselect_b32 s60, s61, s60
    s_lshl_b32 s60, s60, 14
    s_add_u32 s60, s60, s78
    s_add_u32 m0, s79, 118784
    s_add_u32 s61, s60, 8192
    buffer_load_dwordx4 v10, s[52:55], s60 offen lds
    s_add_u32 m0, s79, 119808
    s_nop 0
    buffer_load_dwordx4 v10, s[52:55], s61 offen lds
    s_waitcnt vmcnt(6)
    ds_read_b64_tr_b16 v[146:147], v11 offset:10240
    ds_read_b64_tr_b16 v[150:151], v12 offset:10240
    ds_read_b64_tr_b16 v[154:155], v13 offset:10240
    ds_read_b64_tr_b16 v[158:159], v14 offset:10240
    s_waitcnt lgkmcnt(4)
    s_waitcnt lgkmcnt(0)
    s_add_u32 s60, s74, 25
    s_sub_u32 s61, s60, 28
    s_cmp_ge_u32 s60, 28
    s_cselect_b32 s60, s61, s60
    s_lshl_b32 s60, s60, 14
    s_add_u32 s60, s60, s78
    s_add_u32 m0, s79, 120832
    s_add_u32 s61, s60, 8192
    buffer_load_dwordx4 v10, s[52:55], s60 offen lds
    s_add_u32 m0, s79, 121856
    s_nop 0
    buffer_load_dwordx4 v10, s[52:55], s61 offen lds
    s_waitcnt vmcnt(6)
    ds_read_b64_tr_b16 v[160:161], v11 offset:49152
    ds_read_b64_tr_b16 v[164:165], v12 offset:49152
    ds_read_b64_tr_b16 v[168:169], v13 offset:49152
    ds_read_b64_tr_b16 v[172:173], v14 offset:49152
    s_waitcnt lgkmcnt(0)
    s_add_u32 s60, s73, 6
    s_sub_u32 s61, s60, 28
    s_cmp_ge_u32 s60, 28
    s_cselect_b32 s60, s61, s60
    s_lshl_b32 s60, s60, 14
    s_add_u32 s60, s60, s78
    s_add_u32 m0, s79, 122880
    s_add_u32 s61, s60, 8192
    buffer_load_dwordx4 v10, s[52:55], s60 offen lds
    s_add_u32 m0, s79, 123904
    s_nop 0
    buffer_load_dwordx4 v10, s[52:55], s61 offen lds
    s_waitcnt lgkmcnt(0)
    s_add_u32 s60, s73, 7
    s_sub_u32 s61, s60, 28
    s_cmp_ge_u32 s60, 28
    s_cselect_b32 s60, s61, s60
    s_lshl_b32 s60, s60, 14
    s_add_u32 s60, s60, s78
    s_add_u32 m0, s79, 124928
    s_add_u32 s61, s60, 8192
    buffer_load_dwordx4 v10, s[52:55], s60 offen lds
    s_add_u32 m0, s79, 125952
    s_nop 0
    buffer_load_dwordx4 v10, s[52:55], s61 offen lds
    s_waitcnt lgkmcnt(0)
    s_add_u32 s60, s73, 10
    s_sub_u32 s61, s60, 28
    s_cmp_ge_u32 s60, 28
    s_cselect_b32 s60, s61, s60
    s_lshl_b32 s60, s60, 14
    s_add_u32 s60, s60, s78
    s_add_u32 m0, s79, 65536
    s_add_u32 s61, s60, 8192
    buffer_load_dwordx4 v10, s[52:55], s60 offen lds
    s_add_u32 m0, s79, 66560
    s_nop 0
    buffer_load_dwordx4 v10, s[52:55], s61 offen lds
    s_waitcnt vmcnt(10)
    ds_read_b64_tr_b16 v[162:163], v11 offset:51200
    ds_read_b64_tr_b16 v[166:167], v12 offset:51200
    ds_read_b64_tr_b16 v[170:171], v13 offset:51200
    ds_read_b64_tr_b16 v[174:175], v14 offset:51200
    s_waitcnt lgkmcnt(0)
    s_add_u32 s60, s73, 11
    s_sub_u32 s61, s60, 28
    s_cmp_ge_u32 s60, 28
    s_cselect_b32 s60, s61, s60
    s_lshl_b32 s60, s60, 14
    s_add_u32 s60, s60, s78
    s_add_u32 m0, s79, 67584
    s_add_u32 s61, s60, 8192
    buffer_load_dwordx4 v10, s[52:55], s60 offen lds
    s_add_u32 m0, s79, 68608
    s_nop 0
    buffer_load_dwordx4 v10, s[52:55], s61 offen lds
    s_waitcnt vmcnt(10)
    ds_read_b64_tr_b16 v[176:177], v11 offset:53248
    ds_read_b64_tr_b16 v[180:181], v12 offset:53248
    ds_read_b64_tr_b16 v[184:185], v13 offset:53248
    ds_read_b64_tr_b16 v[188:189], v14 offset:53248
    s_waitcnt lgkmcnt(4)
    s_waitcnt lgkmcnt(0)
    s_add_u32 s60, s73, 14
    s_sub_u32 s61, s60, 28
    s_cmp_ge_u32 s60, 28
    s_cselect_b32 s60, s61, s60
    s_lshl_b32 s60, s60, 14
    s_add_u32 s60, s60, s78
    s_add_u32 m0, s79, 69632
    s_add_u32 s61, s60, 8192
    buffer_load_dwordx4 v10, s[52:55], s60 offen lds
    s_add_u32 m0, s79, 70656
    s_nop 0
    buffer_load_dwordx4 v10, s[52:55], s61 offen lds
    s_waitcnt vmcnt(10)
    ds_read_b64_tr_b16 v[178:179], v11 offset:55296
    ds_read_b64_tr_b16 v[182:183], v12 offset:55296
    ds_read_b64_tr_b16 v[186:187], v13 offset:55296
    ds_read_b64_tr_b16 v[190:191], v14 offset:55296
    s_waitcnt lgkmcnt(0)
    s_add_u32 s60, s73, 15
    s_sub_u32 s61, s60, 28
    s_cmp_ge_u32 s60, 28
    s_cselect_b32 s60, s61, s60
    s_lshl_b32 s60, s60, 14
    s_add_u32 s60, s60, s78
    s_add_u32 m0, s79, 71680
    s_add_u32 s61, s60, 8192
    buffer_load_dwordx4 v10, s[52:55], s60 offen lds
    s_add_u32 m0, s79, 72704
    s_nop 0
    buffer_load_dwordx4 v10, s[52:55], s61 offen lds
    s_waitcnt vmcnt(10)
    s_waitcnt lgkmcnt(0)
    s_add_u32 s60, s73, 18
    s_sub_u32 s61, s60, 28
    s_cmp_ge_u32 s60, 28
    s_cselect_b32 s60, s61, s60
    s_lshl_b32 s60, s60, 14
    s_add_u32 s60, s60, s78
    s_add_u32 m0, s79, 73728
    s_add_u32 s61, s60, 8192
    buffer_load_dwordx4 v10, s[52:55], s60 offen lds
    s_add_u32 m0, s79, 74752
    s_nop 0
    buffer_load_dwordx4 v10, s[52:55], s61 offen lds
    s_waitcnt vmcnt(10)
    s_waitcnt lgkmcnt(0)
    s_add_u32 s60, s73, 19
    s_sub_u32 s61, s60, 28
    s_cmp_ge_u32 s60, 28
    s_cselect_b32 s60, s61, s60
    s_lshl_b32 s60, s60, 14
    s_add_u32 s60, s60, s78
    s_add_u32 m0, s79, 75776
    s_add_u32 s61, s60, 8192
    buffer_load_dwordx4 v10, s[52:55], s60 offen lds
    s_add_u32 m0, s79, 76800
    s_nop 0
    buffer_load_dwordx4 v10, s[52:55], s61 offen lds
    v_min_u32 v4, 6, v0
    v_lshlrev_b32 v4, 7, v4
    s_lshl_b32 s75, s37, 2
    s_add_u32 s75, s75, s77
    s_lshl_b32 s75, s75, 10
    s_add_u32 s75, s75, 655360
    buffer_load_dwordx2 v[6:7], v4, s[40:43], s75 offen sc1
    s_waitcnt vmcnt(11)
    s_waitcnt lgkmcnt(0)
    s_add_u32 s60, s73, 22
    s_sub_u32 s61, s60, 28
    s_cmp_ge_u32 s60, 28
    s_cselect_b32 s60, s61, s60
    s_lshl_b32 s60, s60, 14
    s_add_u32 s60, s60, s78
    s_add_u32 m0, s79, 114688
    s_add_u32 s61, s60, 8192
    buffer_load_dwordx4 v10, s[52:55], s60 offen lds
    s_add_u32 m0, s79, 115712
    s_nop 0
    buffer_load_dwordx4 v10, s[52:55], s61 offen lds
    s_waitcnt vmcnt(11)
    s_waitcnt lgkmcnt(0)
    s_add_u32 s60, s73, 23
    s_sub_u32 s61, s60, 28
    s_cmp_ge_u32 s60, 28
    s_cselect_b32 s60, s61, s60
    s_lshl_b32 s60, s60, 14
    s_add_u32 s60, s60, s78
    s_add_u32 m0, s79, 116736
    s_add_u32 s61, s60, 8192
    buffer_load_dwordx4 v10, s[52:55], s60 offen lds
    s_add_u32 m0, s79, 117760
    s_nop 0
    buffer_load_dwordx4 v10, s[52:55], s61 offen lds
    s_waitcnt vmcnt(11)
    s_waitcnt lgkmcnt(0)
    s_add_u32 s60, s73, 26
    s_sub_u32 s61, s60, 28
    s_cmp_ge_u32 s60, 28
    s_cselect_b32 s60, s61, s60
    s_lshl_b32 s60, s60, 14
    s_add_u32 s60, s60, s78
    s_add_u32 m0, s79, 118784
    s_add_u32 s61, s60, 8192
    buffer_load_dwordx4 v10, s[52:55], s60 offen lds
    s_add_u32 m0, s79, 119808
    s_nop 0
    buffer_load_dwordx4 v10, s[52:55], s61 offen lds
    s_waitcnt vmcnt(11)
    s_waitcnt lgkmcnt(0)
    s_add_u32 s60, s73, 27
    s_sub_u32 s61, s60, 28
    s_cmp_ge_u32 s60, 28
    s_cselect_b32 s60, s61, s60
    s_lshl_b32 s60, s60, 14
    s_add_u32 s60, s60, s78
    s_add_u32 m0, s79, 120832
    s_add_u32 s61, s60, 8192
    buffer_load_dwordx4 v10, s[52:55], s60 offen lds
    s_add_u32 m0, s79, 121856
    s_nop 0
    buffer_load_dwordx4 v10, s[52:55], s61 offen lds
    s_waitcnt vmcnt(8)
L_G2:
    v_mov_b32 v3, 0
    s_mul_i32 s62, s37, 28
    s_mul_i32 s63, s77, 7
    s_add_u32 s62, s62, s63
    s_lshl_b32 s62, s62, 12
    s_add_u32 s62, s62, 7340032
    v_lshlrev_b32 v8, 4, v0
    v_cmp_ne_u64 vcc, s[70:71], v[6:7]
    s_cbranch_vccz L_HAOK
    s_mov_b32 s72, 100000
POLL_18:
    buffer_load_dwordx2 v[6:7], v4, s[40:43], s75 offen sc1
    s_waitcnt vmcnt(0)
    v_cmp_ne_u64 vcc, s[70:71], v[6:7]
    s_cbranch_vccz POLLD_19
    s_sleep 1
    s_sub_u32 s72, s72, 1
    s_cmp_lg_u32 s72, 0
    s_cbranch_scc1 POLL_18
POLLD_19:
L_HAOK:
    s_add_u32 s75, s75, 262144
    s_add_u32 s63, s74, 0
    s_sub_u32 s61, s63, 28
    s_cmp_ge_u32 s63, 28
    s_cselect_b32 s63, s61, s63
    s_lshl_b32 s63, s63, 10
    s_add_u32 s63, s63, s62
    buffer_load_dwordx4 v[208:211], v8, s[40:43], s63 offen offset:0 sc1
    buffer_load_dwordx4 v[212:215], v8, s[40:43], s63 offen offset:1024 sc1
    buffer_load_dwordx4 v[216:219], v8, s[40:43], s63 offen offset:2048 sc1
    buffer_load_dwordx4 v[220:223], v8, s[40:43], s63 offen offset:3072 sc1
    s_add_u32 s63, s74, 4
    s_sub_u32 s61, s63, 28
    s_cmp_ge_u32 s63, 28
    s_cselect_b32 s63, s61, s63
    s_lshl_b32 s63, s63, 10
    s_add_u32 s63, s63, s62
    buffer_load_dwordx4 v[224:227], v8, s[40:43], s63 offen offset:0 sc1
    buffer_load_dwordx4 v[228:231], v8, s[40:43], s63 offen offset:1024 sc1
    buffer_load_dwordx4 v[232:235], v8, s[40:43], s63 offen offset:2048 sc1
    buffer_load_dwordx4 v[236:239], v8, s[40:43], s63 offen offset:3072 sc1
    s_add_u32 s63, s74, 8
    s_sub_u32 s61, s63, 28
    s_cmp_ge_u32 s63, 28
    s_cselect_b32 s63, s61, s63
    s_lshl_b32 s63, s63, 10
    s_add_u32 s63, s63, s62
    buffer_load_dwordx4 v[240:243], v8, s[40:43], s63 offen offset:0 sc1
    buffer_load_dwordx4 v[244:247], v8, s[40:43], s63 offen offset:1024 sc1
    buffer_load_dwordx4 v[248:251], v8, s[40:43], s63 offen offset:2048 sc1
    buffer_load_dwordx4 v[252:255], v8, s[40:43], s63 offen offset:3072 sc1
    s_waitcnt vmcnt(10)
    v_mfma_f32_16x16x32_bf16 v[16:19], v[80:83], v[208:211], 0
    v_mfma_f32_16x16x32_bf16 v[32:35], v[80:83], v[212:215], 0
    v_mfma_f32_16x16x32_bf16 v[36:39], v[84:87], v[212:215], 0
    v_mfma_f32_16x16x32_bf16 v[20:23], v[84:87], v[208:211], 0
    v_mfma_f32_16x16x32_bf16 v[24:27], v[88:91], v[208:211], 0
    v_mfma_f32_16x16x32_bf16 v[40:43], v[88:91], v[212:215], 0
    v_mfma_f32_16x16x32_bf16 v[44:47], v[92:95], v[212:215], 0
    v_mfma_f32_16x16x32_bf16 v[28:31], v[92:95], v[208:211], 0
    s_add_u32 s63, s74, 12
    s_sub_u32 s61, s63, 28
    s_cmp_ge_u32 s63, 28
    s_cselect_b32 s63, s61, s63
    s_lshl_b32 s63, s63, 10
    s_add_u32 s63, s63, s62
    buffer_load_dwordx4 v[208:211], v8, s[40:43], s63 offen offset:0 sc1
    buffer_load_dwordx4 v[212:215], v8, s[40:43], s63 offen offset:1024 sc1
    s_waitcnt vmcnt(10)
    v_mfma_f32_16x16x32_bf16 v[48:51], v[80:83], v[216:219], 0
    v_mfma_f32_16x16x32_bf16 v[64:67], v[80:83], v[220:223], 0
    v_mfma_f32_16x16x32_bf16 v[68:71], v[84:87], v[220:223], 0
    v_mfma_f32_16x16x32_bf16 v[52:55], v[84:87], v[216:219], 0
    v_mfma_f32_16x16x32_bf16 v[56:59], v[88:91], v[216:219], 0
    v_mfma_f32_16x16x32_bf16 v[72:75], v[88:91], v[220:223], 0
    v_mfma_f32_16x16x32_bf16 v[76:79], v[92:95], v[220:223], 0
    v_mfma_f32_16x16x32_bf16 v[60:63], v[92:95], v[216:219], 0
    buffer_load_dwordx4 v[216:219], v8, s[40:43], s63 offen offset:2048 sc1
    buffer_load_dwordx4 v[220:223], v8, s[40:43], s63 offen offset:3072 sc1
    s_waitcnt vmcnt(10)
    v_mfma_f32_16x16x32_bf16 v[16:19], v[96:99], v[224:227], v[16:19]
    v_mfma_f32_16x16x32_bf16 v[32:35], v[96:99], v[228:231], v[32:35]
    v_mfma_f32_16x16x32_bf16 v[36:39], v[100:103], v[228:231], v[36:39]
    v_mfma_f32_16x16x32_bf16 v[20:23], v[100:103], v[224:227], v[20:23]
    v_mfma_f32_16x16x32_bf16 v[24:27], v[104:107], v[224:227], v[24:27]
    v_mfma_f32_16x16x32_bf16 v[40:43], v[104:107], v[228:231], v[40:43]
    v_mfma_f32_16x16x32_bf16 v[44:47], v[108:111], v[228:231], v[44:47]
    v_mfma_f32_16x16x32_bf16 v[28:31], v[108:111], v[224:227], v[28:31]
    s_add_u32 s63, s74, 16
    s_sub_u32 s61, s63, 28
    s_cmp_ge_u32 s63, 28
    s_cselect_b32 s63, s61, s63
    s_lshl_b32 s63, s63, 10
    s_add_u32 s63, s63, s62
    buffer_load_dwordx4 v[80:83], v8, s[40:43], s63 offen offset:0 sc1
    buffer_load_dwordx4 v[84:87], v8, s[40:43], s63 offen offset:1024 sc1
    s_waitcnt vmcnt(10)
    v_mfma_f32_16x16x32_bf16 v[48:51], v[96:99], v[232:235], v[48:51]
    v_mfma_f32_16x16x32_bf16 v[64:67], v[96:99], v[236:239], v[64:67]
    v_mfma_f32_16x16x32_bf16 v[68:71], v[100:103], v[236:239], v[68:71]
    v_mfma_f32_16x16x32_bf16 v[52:55], v[100:103], v[232:235], v[52:55]
    v_mfma_f32_16x16x32_bf16 v[56:59], v[104:107], v[232:235], v[56:59]
    v_mfma_f32_16x16x32_bf16 v[72:75], v[104:107], v[236:239], v[72:75]
    v_mfma_f32_16x16x32_bf16 v[76:79], v[108:111], v[236:239], v[76:79]
    v_mfma_f32_16x16x32_bf16 v[60:63], v[108:111], v[232:235], v[60:63]
    buffer_load_dwordx4 v[88:91], v8, s[40:43], s63 offen offset:2048 sc1
    buffer_load_dwordx4 v[92:95], v8, s[40:43], s63 offen offset:3072 sc1
    s_waitcnt vmcnt(10)
    v_mfma_f32_16x16x32_bf16 v[16:19], v[112:115], v[240:243], v[16:19]
    v_mfma_f32_16x16x32_bf16 v[32:35], v[112:115], v[244:247], v[32:35]
    v_mfma_f32_16x16x32_bf16 v[36:39], v[116:119], v[244:247], v[36:39]
    v_mfma_f32_16x16x32_bf16 v[20:23], v[116:119], v[240:243], v[20:23]
    v_mfma_f32_16x16x32_bf16 v[24:27], v[120:123], v[240:243], v[24:27]
    v_mfma_f32_16x16x32_bf16 v[40:43], v[120:123], v[244:247], v[40:43]
    v_mfma_f32_16x16x32_bf16 v[44:47], v[124:127], v[244:247], v[44:47]
    v_mfma_f32_16x16x32_bf16 v[28:31], v[124:127], v[240:243], v[28:31]
    s_add_u32 s63, s74, 20
    s_sub_u32 s61, s63, 28
    s_cmp_ge_u32 s63, 28
    s_cselect_b32 s63, s61, s63
    s_lshl_b32 s63, s63, 10
    s_add_u32 s63, s63, s62
    buffer_load_dwordx4 v[224:227], v8, s[40:43], s63 offen offset:0 sc1
    buffer_load_dwordx4 v[228:231], v8, s[40:43], s63 offen offset:1024 sc1
    buffer_load_dwordx2 v[6:7], v4, s[40:43], s75 offen sc1
    s_waitcnt vmcnt(11)
    v_mfma_f32_16x16x32_bf16 v[48:51], v[112:115], v[248:251], v[48:51]
    v_mfma_f32_16x16x32_bf16 v[64:67], v[112:115], v[252:255], v[64:67]
    v_mfma_f32_16x16x32_bf16 v[68:71], v[116:119], v[252:255], v[68:71]
    v_mfma_f32_16x16x32_bf16 v[52:55], v[116:119], v[248:251], v[52:55]
    v_mfma_f32_16x16x32_bf16 v[56:59], v[120:123], v[248:251], v[56:59]
    v_mfma_f32_16x16x32_bf16 v[72:75], v[120:123], v[252:255], v[72:75]
    v_mfma_f32_16x16x32_bf16 v[76:79], v[124:127], v[252:255], v[76:79]
    v_mfma_f32_16x16x32_bf16 v[60:63], v[124:127], v[248:251], v[60:63]
    buffer_load_dwordx4 v[232:235], v8, s[40:43], s63 offen offset:2048 sc1
    buffer_load_dwordx4 v[236:239], v8, s[40:43], s63 offen offset:3072 sc1
    s_waitcnt vmcnt(11)
    v_mfma_f32_16x16x32_bf16 v[16:19], v[128:131], v[208:211], v[16:19]
    v_mfma_f32_16x16x32_bf16 v[32:35], v[128:131], v[212:215], v[32:35]
    v_mfma_f32_16x16x32_bf16 v[36:39], v[132:135], v[212:215], v[36:39]
    v_mfma_f32_16x16x32_bf16 v[20:23], v[132:135], v[208:211], v[20:23]
    v_mfma_f32_16x16x32_bf16 v[24:27], v[136:139], v[208:211], v[24:27]
    v_mfma_f32_16x16x32_bf16 v[40:43], v[136:139], v[212:215], v[40:43]
    v_mfma_f32_16x16x32_bf16 v[44:47], v[140:143], v[212:215], v[44:47]
    v_mfma_f32_16x16x32_bf16 v[28:31], v[140:143], v[208:211], v[28:31]
    s_add_u32 s63, s74, 24
    s_sub_u32 s61, s63, 28
    s_cmp_ge_u32 s63, 28
    s_cselect_b32 s63, s61, s63
    s_lshl_b32 s63, s63, 10
    s_add_u32 s63, s63, s62
    buffer_load_dwordx4 v[96:99], v8, s[40:43], s63 offen offset:0 sc1
    buffer_load_dwordx4 v[100:103], v8, s[40:43], s63 offen offset:1024 sc1
    s_waitcnt vmcnt(11)
    v_mfma_f32_16x16x32_bf16 v[48:51], v[128:131], v[216:219], v[48:51]
    v_mfma_f32_16x16x32_bf16 v[64:67], v[128:131], v[220:223], v[64:67]
    v_mfma_f32_16x16x32_bf16 v[68:71], v[132:135], v[220:223], v[68:71]
    v_mfma_f32_16x16x32_bf16 v[52:55], v[132:135], v[216:219], v[52:55]
    v_mfma_f32_16x16x32_bf16 v[56:59], v[136:139], v[216:219], v[56:59]
    v_mfma_f32_16x16x32_bf16 v[72:75], v[136:139], v[220:223], v[72:75]
    v_mfma_f32_16x16x32_bf16 v[76:79], v[140:143], v[220:223], v[76:79]
    v_mfma_f32_16x16x32_bf16 v[60:63], v[140:143], v[216:219], v[60:63]
    buffer_load_dwordx4 v[104:107], v8, s[40:43], s63 offen offset:2048 sc1
    buffer_load_dwordx4 v[108:111], v8, s[40:43], s63 offen offset:3072 sc1
    s_waitcnt vmcnt(11)
    v_mfma_f32_16x16x32_bf16 v[16:19], v[144:147], v[80:83], v[16:19]
    v_mfma_f32_16x16x32_bf16 v[32:35], v[144:147], v[84:87], v[32:35]
    v_mfma_f32_16x16x32_bf16 v[36:39], v[148:151], v[84:87], v[36:39]
    v_mfma_f32_16x16x32_bf16 v[20:23], v[148:151], v[80:83], v[20:23]
    v_mfma_f32_16x16x32_bf16 v[24:27], v[152:155], v[80:83], v[24:27]
    v_mfma_f32_16x16x32_bf16 v[40:43], v[152:155], v[84:87], v[40:43]
    v_mfma_f32_16x16x32_bf16 v[44:47], v[156:159], v[84:87], v[44:47]
    v_mfma_f32_16x16x32_bf16 v[28:31], v[156:159], v[80:83], v[28:31]
    s_waitcnt vmcnt(6)
    v_cmp_ne_u64 vcc, s[70:71], v[6:7]
    s_cbranch_vccz L_HBOK
    s_mov_b32 s72, 100000
POLL_20:
    buffer_load_dwordx2 v[6:7], v4, s[40:43], s75 offen sc1
    s_waitcnt vmcnt(0)
    v_cmp_ne_u64 vcc, s[70:71], v[6:7]
    s_cbranch_vccz POLLD_21
    s_sleep 1
    s_sub_u32 s72, s72, 1
    s_cmp_lg_u32 s72, 0
    s_cbranch_scc1 POLL_20
POLLD_21:
L_HBOK:
    s_add_u32 s63, s73, 0
    s_sub_u32 s61, s63, 28
    s_cmp_ge_u32 s63, 28
    s_cselect_b32 s63, s61, s63
    s_lshl_b32 s63, s63, 10
    s_add_u32 s63, s63, s62
    s_add_u32 s63, s63, 3670016
    buffer_load_dwordx4 v[240:243], v8, s[40:43], s63 offen offset:0 sc1
    buffer_load_dwordx4 v[244:247], v8, s[40:43], s63 offen offset:1024 sc1
    s_waitcnt vmcnt(11)
    v_mfma_f32_16x16x32_bf16 v[48:51], v[144:147], v[88:91], v[48:51]
    v_mfma_f32_16x16x32_bf16 v[64:67], v[144:147], v[92:95], v[64:67]
    v_mfma_f32_16x16x32_bf16 v[68:71], v[148:151], v[92:95], v[68:71]
    v_mfma_f32_16x16x32_bf16 v[52:55], v[148:151], v[88:91], v[52:55]
    v_mfma_f32_16x16x32_bf16 v[56:59], v[152:155], v[88:91], v[56:59]
    v_mfma_f32_16x16x32_bf16 v[72:75], v[152:155], v[92:95], v[72:75]
    v_mfma_f32_16x16x32_bf16 v[76:79], v[156:159], v[92:95], v[76:79]
    v_mfma_f32_16x16x32_bf16 v[60:63], v[156:159], v[88:91], v[60:63]
    buffer_load_dwordx4 v[248:251], v8, s[40:43], s63 offen offset:2048 sc1
    buffer_load_dwordx4 v[252:255], v8, s[40:43], s63 offen offset:3072 sc1
    s_waitcnt vmcnt(11)
    v_mfma_f32_16x16x32_bf16 v[16:19], v[160:163], v[224:227], v[16:19]
    v_mfma_f32_16x16x32_bf16 v[32:35], v[160:163], v[228:231], v[32:35]
    v_mfma_f32_16x16x32_bf16 v[36:39], v[164:167], v[228:231], v[36:39]
    v_mfma_f32_16x16x32_bf16 v[20:23], v[164:167], v[224:227], v[20:23]
    v_mfma_f32_16x16x32_bf16 v[24:27], v[168:171], v[224:227], v[24:27]
    v_mfma_f32_16x16x32_bf16 v[40:43], v[168:171], v[228:231], v[40:43]
    v_mfma_f32_16x16x32_bf16 v[44:47], v[172:175], v[228:231], v[44:47]
    v_mfma_f32_16x16x32_bf16 v[28:31], v[172:175], v[224:227], v[28:31]
    s_add_u32 s63, s73, 4
    s_sub_u32 s61, s63, 28
    s_cmp_ge_u32 s63, 28
    s_cselect_b32 s63, s61, s63
    s_lshl_b32 s63, s63, 10
    s_add_u32 s63, s63, s62
    s_add_u32 s63, s63, 3670016
    buffer_load_dwordx4 v[112:115], v8, s[40:43], s63 offen offset:0 sc1
    buffer_load_dwordx4 v[116:119], v8, s[40:43], s63 offen offset:1024 sc1
    s_waitcnt vmcnt(10)
    v_mfma_f32_16x16x32_bf16 v[48:51], v[160:163], v[232:235], v[48:51]
    v_mfma_f32_16x16x32_bf16 v[64:67], v[160:163], v[236:239], v[64:67]
    v_mfma_f32_16x16x32_bf16 v[68:71], v[164:167], v[236:239], v[68:71]
    v_mfma_f32_16x16x32_bf16 v[52:55], v[164:167], v[232:235], v[52:55]
    v_mfma_f32_16x16x32_bf16 v[56:59], v[168:171], v[232:235], v[56:59]
    v_mfma_f32_16x16x32_bf16 v[72:75], v[168:171], v[236:239], v[72:75]
    v_mfma_f32_16x16x32_bf16 v[76:79], v[172:175], v[236:239], v[76:79]
    v_mfma_f32_16x16x32_bf16 v[60:63], v[172:175], v[232:235], v[60:63]
    buffer_load_dwordx4 v[120:123], v8, s[40:43], s63 offen offset:2048 sc1
    buffer_load_dwordx4 v[124:127], v8, s[40:43], s63 offen offset:3072 sc1
    s_waitcnt vmcnt(10)
    v_mfma_f32_16x16x32_bf16 v[16:19], v[176:179], v[96:99], v[16:19]
    v_mfma_f32_16x16x32_bf16 v[32:35], v[176:179], v[100:103], v[32:35]
    v_mfma_f32_16x16x32_bf16 v[36:39], v[180:183], v[100:103], v[36:39]
    v_mfma_f32_16x16x32_bf16 v[20:23], v[180:183], v[96:99], v[20:23]
    v_mfma_f32_16x16x32_bf16 v[24:27], v[184:187], v[96:99], v[24:27]
    v_mfma_f32_16x16x32_bf16 v[40:43], v[184:187], v[100:103], v[40:43]
    v_mfma_f32_16x16x32_bf16 v[44:47], v[188:191], v[100:103], v[44:47]
    v_mfma_f32_16x16x32_bf16 v[28:31], v[188:191], v[96:99], v[28:31]
    s_add_u32 s63, s73, 8
    s_sub_u32 s61, s63, 28
    s_cmp_ge_u32 s63, 28
    s_cselect_b32 s63, s61, s63
    s_lshl_b32 s63, s63, 10
    s_add_u32 s63, s63, s62
    s_add_u32 s63, s63, 3670016
    buffer_load_dwordx4 v[208:211], v8, s[40:43], s63 offen offset:0 sc1
    buffer_load_dwordx4 v[212:215], v8, s[40:43], s63 offen offset:1024 sc1
    s_waitcnt vmcnt(10)
    v_mfma_f32_16x16x32_bf16 v[48:51], v[176:179], v[104:107], v[48:51]
    v_mfma_f32_16x16x32_bf16 v[64:67], v[176:179], v[108:111], v[64:67]
    v_mfma_f32_16x16x32_bf16 v[68:71], v[180:183], v[108:111], v[68:71]
    v_mfma_f32_16x16x32_bf16 v[52:55], v[180:183], v[104:107], v[52:55]
    v_mfma_f32_16x16x32_bf16 v[56:59], v[184:187], v[104:107], v[56:59]
    v_mfma_f32_16x16x32_bf16 v[72:75], v[184:187], v[108:111], v[72:75]
    v_mfma_f32_16x16x32_bf16 v[76:79], v[188:191], v[108:111], v[76:79]
    v_mfma_f32_16x16x32_bf16 v[60:63], v[188:191], v[104:107], v[60:63]
    buffer_load_dwordx4 v[216:219], v8, s[40:43], s63 offen offset:2048 sc1
    buffer_load_dwordx4 v[220:223], v8, s[40:43], s63 offen offset:3072 sc1
    s_waitcnt vmcnt(10)
    v_mfma_f32_16x16x32_bf16 v[16:19], v[192:195], v[240:243], v[16:19]
    v_mfma_f32_16x16x32_bf16 v[32:35], v[192:195], v[244:247], v[32:35]
    v_mfma_f32_16x16x32_bf16 v[36:39], v[196:199], v[244:247], v[36:39]
    v_mfma_f32_16x16x32_bf16 v[20:23], v[196:199], v[240:243], v[20:23]
    v_mfma_f32_16x16x32_bf16 v[24:27], v[200:203], v[240:243], v[24:27]
    v_mfma_f32_16x16x32_bf16 v[40:43], v[200:203], v[244:247], v[40:43]
    v_mfma_f32_16x16x32_bf16 v[44:47], v[204:207], v[244:247], v[44:47]
    v_mfma_f32_16x16x32_bf16 v[28:31], v[204:207], v[240:243], v[28:31]
    s_add_u32 s63, s73, 12
    s_sub_u32 s61, s63, 28
    s_cmp_ge_u32 s63, 28
    s_cselect_b32 s63, s61, s63
    s_lshl_b32 s63, s63, 10
    s_add_u32 s63, s63, s62
    s_add_u32 s63, s63, 3670016
    buffer_load_dwordx4 v[128:131], v8, s[40:43], s63 offen offset:0 sc1
    buffer_load_dwordx4 v[132:135], v8, s[40:43], s63 offen offset:1024 sc1
    s_waitcnt vmcnt(10)
    v_mfma_f32_16x16x32_bf16 v[48:51], v[192:195], v[248:251], v[48:51]
    ds_read_b64_tr_b16 v[136:137], v11 offset:57344
    v_mfma_f32_16x16x32_bf16 v[64:67], v[192:195], v[252:255], v[64:67]
    ds_read_b64_tr_b16 v[140:141], v12 offset:57344
    v_mfma_f32_16x16x32_bf16 v[68:71], v[196:199], v[252:255], v[68:71]
    ds_read_b64_tr_b16 v[80:81], v13 offset:57344
    v_mfma_f32_16x16x32_bf16 v[52:55], v[196:199], v[248:251], v[52:55]
    ds_read_b64_tr_b16 v[84:85], v14 offset:57344
    v_mfma_f32_16x16x32_bf16 v[56:59], v[200:203], v[248:251], v[56:59]
    ds_read_b64_tr_b16 v[138:139], v11 offset:59392
    v_mfma_f32_16x16x32_bf16 v[72:75], v[200:203], v[252:255], v[72:75]
    ds_read_b64_tr_b16 v[142:143], v12 offset:59392
    v_mfma_f32_16x16x32_bf16 v[76:79], v[204:207], v[252:255], v[76:79]
    ds_read_b64_tr_b16 v[82:83], v13 offset:59392
    v_mfma_f32_16x16x32_bf16 v[60:63], v[204:207], v[248:251], v[60:63]
    ds_read_b64_tr_b16 v[86:87], v14 offset:59392
    buffer_load_dwordx4 v[88:91], v8, s[40:43], s63 offen offset:2048 sc1
    buffer_load_dwordx4 v[92:95], v8, s[40:43], s63 offen offset:3072 sc1
    s_waitcnt vmcnt(10)
    s_waitcnt lgkmcnt(0)
    v_mfma_f32_16x16x32_bf16 v[16:19], v[136:139], v[112:115], v[16:19]
    v_mfma_f32_16x16x32_bf16 v[32:35], v[136:139], v[116:119], v[32:35]
    v_mfma_f32_16x16x32_bf16 v[36:39], v[140:143], v[116:119], v[36:39]
    v_mfma_f32_16x16x32_bf16 v[20:23], v[140:143], v[112:115], v[20:23]
    v_mfma_f32_16x16x32_bf16 v[24:27], v[80:83], v[112:115], v[24:27]
    v_mfma_f32_16x16x32_bf16 v[40:43], v[80:83], v[116:119], v[40:43]
    v_mfma_f32_16x16x32_bf16 v[44:47], v[84:87], v[116:119], v[44:47]
    v_mfma_f32_16x16x32_bf16 v[28:31], v[84:87], v[112:115], v[28:31]
    s_add_u32 s63, s73, 16
    s_sub_u32 s61, s63, 28
    s_cmp_ge_u32 s63, 28
    s_cselect_b32 s63, s61, s63
    s_lshl_b32 s63, s63, 10
    s_add_u32 s63, s63, s62
    s_add_u32 s63, s63, 3670016
    buffer_load_dwordx4 v[144:147], v8, s[40:43], s63 offen offset:0 sc1
    buffer_load_dwordx4 v[148:151], v8, s[40:43], s63 offen offset:1024 sc1
    s_waitcnt vmcnt(10)
    v_mfma_f32_16x16x32_bf16 v[48:51], v[136:139], v[120:123], v[48:51]
    ds_read_b64_tr_b16 v[152:153], v11 offset:0
    v_mfma_f32_16x16x32_bf16 v[64:67], v[136:139], v[124:127], v[64:67]
    ds_read_b64_tr_b16 v[156:157], v12 offset:0
    v_mfma_f32_16x16x32_bf16 v[68:71], v[140:143], v[124:127], v[68:71]
    ds_read_b64_tr_b16 v[224:225], v13 offset:0
    v_mfma_f32_16x16x32_bf16 v[52:55], v[140:143], v[120:123], v[52:55]
    ds_read_b64_tr_b16 v[228:229], v14 offset:0
    v_mfma_f32_16x16x32_bf16 v[56:59], v[80:83], v[120:123], v[56:59]
    ds_read_b64_tr_b16 v[154:155], v11 offset:2048
    v_mfma_f32_16x16x32_bf16 v[72:75], v[80:83], v[124:127], v[72:75]
    ds_read_b64_tr_b16 v[158:159], v12 offset:2048
    v_mfma_f32_16x16x32_bf16 v[76:79], v[84:87], v[124:127], v[76:79]
    ds_read_b64_tr_b16 v[226:227], v13 offset:2048
    v_mfma_f32_16x16x32_bf16 v[60:63], v[84:87], v[120:123], v[60:63]
    ds_read_b64_tr_b16 v[230:231], v14 offset:2048
    buffer_load_dwordx4 v[232:235], v8, s[40:43], s63 offen offset:2048 sc1
    buffer_load_dwordx4 v[236:239], v8, s[40:43], s63 offen offset:3072 sc1
    s_waitcnt vmcnt(10)
    s_waitcnt lgkmcnt(0)
    v_mfma_f32_16x16x32_bf16 v[16:19], v[152:155], v[208:211], v[16:19]
    v_mfma_f32_16x16x32_bf16 v[32:35], v[152:155], v[212:215], v[32:35]
    v_mfma_f32_16x16x32_bf16 v[36:39], v[156:159], v[212:215], v[36:39]
    v_mfma_f32_16x16x32_bf16 v[20:23], v[156:159], v[208:211], v[20:23]
    v_mfma_f32_16x16x32_bf16 v[24:27], v[224:227], v[208:211], v[24:27]
    v_mfma_f32_16x16x32_bf16 v[40:43], v[224:227], v[212:215], v[40:43]
    v_mfma_f32_16x16x32_bf16 v[44:47], v[228:231], v[212:215], v[44:47]
    v_mfma_f32_16x16x32_bf16 v[28:31], v[228:231], v[208:211], v[28:31]
    s_add_u32 s63, s73, 20
    s_sub_u32 s61, s63, 28
    s_cmp_ge_u32 s63, 28
    s_cselect_b32 s63, s61, s63
    s_lshl_b32 s63, s63, 10
    s_add_u32 s63, s63, s62
    s_add_u32 s63, s63, 3670016
    buffer_load_dwordx4 v[160:163], v8, s[40:43], s63 offen offset:0 sc1
    buffer_load_dwordx4 v[164:167], v8, s[40:43], s63 offen offset:1024 sc1
    v_mov_b32 v5, 1
    s_mov_b64 exec, 1
    ds_add_u32 v3, v5 offset:1160
    s_mov_b64 exec, -1
    s_waitcnt vmcnt(10)
    v_mfma_f32_16x16x32_bf16 v[48:51], v[152:155], v[216:219], v[48:51]
    ds_read_b64_tr_b16 v[168:169], v11 offset:4096
    v_mfma_f32_16x16x32_bf16 v[64:67], v[152:155], v[220:223], v[64:67]
    ds_read_b64_tr_b16 v[172:173], v12 offset:4096
    v_mfma_f32_16x16x32_bf16 v[68:71], v[156:159], v[220:223], v[68:71]
    ds_read_b64_tr_b16 v[96:97], v13 offset:4096
    v_mfma_f32_16x16x32_bf16 v[52:55], v[156:159], v[216:219], v[52:55]
    ds_read_b64_tr_b16 v[100:101], v14 offset:4096
    v_mfma_f32_16x16x32_bf16 v[56:59], v[224:227], v[216:219], v[56:59]
    ds_read_b64_tr_b16 v[170:171], v11 offset:6144
    v_mfma_f32_16x16x32_bf16 v[72:75], v[224:227], v[220:223], v[72:75]
    ds_read_b64_tr_b16 v[174:175], v12 offset:6144
    v_mfma_f32_16x16x32_bf16 v[76:79], v[228:231], v[220:223], v[76:79]
    ds_read_b64_tr_b16 v[98:99], v13 offset:6144
    v_mfma_f32_16x16x32_bf16 v[60:63], v[228:231], v[216:219], v[60:63]
    ds_read_b64_tr_b16 v[102:103], v14 offset:6144
    buffer_load_dwordx4 v[104:107], v8, s[40:43], s63 offen offset:2048 sc1
    buffer_load_dwordx4 v[108:111], v8, s[40:43], s63 offen offset:3072 sc1
    s_waitcnt vmcnt(10)
    s_waitcnt lgkmcnt(0)
    v_mfma_f32_16x16x32_bf16 v[16:19], v[168:171], v[128:131], v[16:19]
    v_mfma_f32_16x16x32_bf16 v[32:35], v[168:171], v[132:135], v[32:35]
    v_mfma_f32_16x16x32_bf16 v[36:39], v[172:175], v[132:135], v[36:39]
    v_mfma_f32_16x16x32_bf16 v[20:23], v[172:175], v[128:131], v[20:23]
    v_mfma_f32_16x16x32_bf16 v[24:27], v[96:99], v[128:131], v[24:27]
    v_mfma_f32_16x16x32_bf16 v[40:43], v[96:99], v[132:135], v[40:43]
    v_mfma_f32_16x16x32_bf16 v[44:47], v[100:103], v[132:135], v[44:47]
    v_mfma_f32_16x16x32_bf16 v[28:31], v[100:103], v[128:131], v[28:31]
    s_add_u32 s63, s73, 24
    s_sub_u32 s61, s63, 28
    s_cmp_ge_u32 s63, 28
    s_cselect_b32 s63, s61, s63
    s_lshl_b32 s63, s63, 10
    s_add_u32 s63, s63, s62
    s_add_u32 s63, s63, 3670016
    buffer_load_dwordx4 v[176:179], v8, s[40:43], s63 offen offset:0 sc1
    buffer_load_dwordx4 v[180:183], v8, s[40:43], s63 offen offset:1024 sc1
    s_waitcnt vmcnt(10)
    v_mfma_f32_16x16x32_bf16 v[48:51], v[168:171], v[88:91], v[48:51]
    ds_read_b64_tr_b16 v[184:185], v11 offset:8192
    v_mfma_f32_16x16x32_bf16 v[64:67], v[168:171], v[92:95], v[64:67]
    ds_read_b64_tr_b16 v[188:189], v12 offset:8192
    v_mfma_f32_16x16x32_bf16 v[68:71], v[172:175], v[92:95], v[68:71]
    ds_read_b64_tr_b16 v[240:241], v13 offset:8192
    v_mfma_f32_16x16x32_bf16 v[52:55], v[172:175], v[88:91], v[52:55]
    ds_read_b64_tr_b16 v[244:245], v14 offset:8192
    v_mfma_f32_16x16x32_bf16 v[56:59], v[96:99], v[88:91], v[56:59]
    ds_read_b64_tr_b16 v[186:187], v11 offset:10240
    v_mfma_f32_16x16x32_bf16 v[72:75], v[96:99], v[92:95], v[72:75]
    ds_read_b64_tr_b16 v[190:191], v12 offset:10240
    v_mfma_f32_16x16x32_bf16 v[76:79], v[100:103], v[92:95], v[76:79]
    ds_read_b64_tr_b16 v[242:243], v13 offset:10240
    v_mfma_f32_16x16x32_bf16 v[60:63], v[100:103], v[88:91], v[60:63]
    ds_read_b64_tr_b16 v[246:247], v14 offset:10240
    buffer_load_dwordx4 v[248:251], v8, s[40:43], s63 offen offset:2048 sc1
    buffer_load_dwordx4 v[252:255], v8, s[40:43], s63 offen offset:3072 sc1
    s_waitcnt vmcnt(10)
    s_waitcnt lgkmcnt(0)
    v_mfma_f32_16x16x32_bf16 v[16:19], v[184:187], v[144:147], v[16:19]
    v_mfma_f32_16x16x32_bf16 v[32:35], v[184:187], v[148:151], v[32:35]
    v_mfma_f32_16x16x32_bf16 v[36:39], v[188:191], v[148:151], v[36:39]
    v_mfma_f32_16x16x32_bf16 v[20:23], v[188:191], v[144:147], v[20:23]
    v_mfma_f32_16x16x32_bf16 v[24:27], v[240:243], v[144:147], v[24:27]
    v_mfma_f32_16x16x32_bf16 v[40:43], v[240:243], v[148:151], v[40:43]
    v_mfma_f32_16x16x32_bf16 v[44:47], v[244:247], v[148:151], v[44:47]
    v_mfma_f32_16x16x32_bf16 v[28:31], v[244:247], v[144:147], v[28:31]
    s_waitcnt vmcnt(8)
    v_mfma_f32_16x16x32_bf16 v[48:51], v[184:187], v[232:235], v[48:51]
    ds_read_b64_tr_b16 v[192:193], v11 offset:49152
    v_mfma_f32_16x16x32_bf16 v[64:67], v[184:187], v[236:239], v[64:67]
    ds_read_b64_tr_b16 v[196:197], v12 offset:49152
    v_mfma_f32_16x16x32_bf16 v[68:71], v[188:191], v[236:239], v[68:71]
    ds_read_b64_tr_b16 v[200:201], v13 offset:49152
    v_mfma_f32_16x16x32_bf16 v[52:55], v[188:191], v[232:235], v[52:55]
    ds_read_b64_tr_b16 v[204:205], v14 offset:49152
    v_mfma_f32_16x16x32_bf16 v[56:59], v[240:243], v[232:235], v[56:59]
    ds_read_b64_tr_b16 v[194:195], v11 offset:51200
    v_mfma_f32_16x16x32_bf16 v[72:75], v[240:243], v[236:239], v[72:75]
    ds_read_b64_tr_b16 v[198:199], v12 offset:51200
    v_mfma_f32_16x16x32_bf16 v[76:79], v[244:247], v[236:239], v[76:79]
    ds_read_b64_tr_b16 v[202:203], v13 offset:51200
    v_mfma_f32_16x16x32_bf16 v[60:63], v[244:247], v[232:235], v[60:63]
    ds_read_b64_tr_b16 v[206:207], v14 offset:51200
    s_waitcnt vmcnt(6)
    s_waitcnt lgkmcnt(0)
    v_mfma_f32_16x16x32_bf16 v[16:19], v[192:195], v[160:163], v[16:19]
    v_mfma_f32_16x16x32_bf16 v[32:35], v[192:195], v[164:167], v[32:35]
    v_mfma_f32_16x16x32_bf16 v[36:39], v[196:199], v[164:167], v[36:39]
    v_mfma_f32_16x16x32_bf16 v[20:23], v[196:199], v[160:163], v[20:23]
    v_mfma_f32_16x16x32_bf16 v[24:27], v[200:203], v[160:163], v[24:27]
    v_mfma_f32_16x16x32_bf16 v[40:43], v[200:203], v[164:167], v[40:43]
    v_mfma_f32_16x16x32_bf16 v[44:47], v[204:207], v[164:167], v[44:47]
    v_mfma_f32_16x16x32_bf16 v[28:31], v[204:207], v[160:163], v[28:31]
    v_and_b32 v3, 15, v0
    v_lshrrev_b32 v4, 4, v0
    v_and_b32 v5, 7, v0
    v_xor_b32 v4, v4, v5
    v_lshlrev_b32 v4, 4, v4
    v_lshl_add_u32 v4, v3, 8, v4
    s_add_u32 s60, s79, 65536
    v_add_u32 v4, s60, v4
    v_xor_b32 v5, 64, v4
    s_waitcnt vmcnt(4)
    v_mfma_f32_16x16x32_bf16 v[48:51], v[192:195], v[104:107], v[48:51]
    ds_read_b64_tr_b16 v[112:113], v11 offset:53248
    v_mfma_f32_16x16x32_bf16 v[64:67], v[192:195], v[108:111], v[64:67]
    ds_read_b64_tr_b16 v[116:117], v12 offset:53248
    v_mfma_f32_16x16x32_bf16 v[68:71], v[196:199], v[108:111], v[68:71]
    ds_read_b64_tr_b16 v[120:121], v13 offset:53248
    v_mfma_f32_16x16x32_bf16 v[52:55], v[196:199], v[104:107], v[52:55]
    ds_read_b64_tr_b16 v[124:125], v14 offset:53248
    v_mfma_f32_16x16x32_bf16 v[56:59], v[200:203], v[104:107], v[56:59]
    ds_read_b64_tr_b16 v[114:115], v11 offset:55296
    v_mfma_f32_16x16x32_bf16 v[72:75], v[200:203], v[108:111], v[72:75]
    ds_read_b64_tr_b16 v[118:119], v12 offset:55296
    v_mfma_f32_16x16x32_bf16 v[76:79], v[204:207], v[108:111], v[76:79]
    ds_read_b64_tr_b16 v[122:123], v13 offset:55296
    v_mfma_f32_16x16x32_bf16 v[60:63], v[204:207], v[104:107], v[60:63]
    ds_read_b64_tr_b16 v[126:127], v14 offset:55296
    s_waitcnt vmcnt(2)
    s_waitcnt lgkmcnt(0)
    v_mfma_f32_16x16x32_bf16 v[16:19], v[112:115], v[176:179], v[16:19]
    v_mfma_f32_16x16x32_bf16 v[32:35], v[112:115], v[180:183], v[32:35]
    v_mfma_f32_16x16x32_bf16 v[36:39], v[116:119], v[180:183], v[36:39]
    v_mfma_f32_16x16x32_bf16 v[20:23], v[116:119], v[176:179], v[20:23]
    v_mfma_f32_16x16x32_bf16 v[24:27], v[120:123], v[176:179], v[24:27]
    v_mfma_f32_16x16x32_bf16 v[40:43], v[120:123], v[180:183], v[40:43]
    v_mfma_f32_16x16x32_bf16 v[44:47], v[124:127], v[180:183], v[44:47]
    v_mfma_f32_16x16x32_bf16 v[28:31], v[124:127], v[176:179], v[28:31]
    s_nop 0
    ds_write_b128 v4, v[16:19] offset:0
    s_nop 1
    ds_write_b128 v5, v[20:23] offset:0
    ds_write_b128 v4, v[24:27] offset:128
    s_nop 1
    ds_write_b128 v5, v[28:31] offset:128
    ds_write_b128 v4, v[32:35] offset:4096
    ds_write_b128 v5, v[36:39] offset:4096
    ds_write_b128 v4, v[40:43] offset:4224
    ds_write_b128 v5, v[44:47] offset:4224
    s_waitcnt vmcnt(0)
    v_mfma_f32_16x16x32_bf16 v[48:51], v[112:115], v[248:251], v[48:51]
    v_mfma_f32_16x16x32_bf16 v[64:67], v[112:115], v[252:255], v[64:67]
    v_mfma_f32_16x16x32_bf16 v[68:71], v[116:119], v[252:255], v[68:71]
    v_mfma_f32_16x16x32_bf16 v[52:55], v[116:119], v[248:251], v[52:55]
    v_mfma_f32_16x16x32_bf16 v[56:59], v[120:123], v[248:251], v[56:59]
    v_mfma_f32_16x16x32_bf16 v[72:75], v[120:123], v[252:255], v[72:75]
    v_mfma_f32_16x16x32_bf16 v[76:79], v[124:127], v[252:255], v[76:79]
    v_mfma_f32_16x16x32_bf16 v[60:63], v[124:127], v[248:251], v[60:63]
    s_nop 0
    ds_write_b128 v4, v[48:51] offset:49152
    s_nop 1
    ds_write_b128 v5, v[52:55] offset:49152
    ds_write_b128 v4, v[56:59] offset:49280
    s_nop 1
    ds_write_b128 v5, v[60:63] offset:49280
    ds_write_b128 v4, v[64:67] offset:53248
    ds_write_b128 v5, v[68:71] offset:53248
    ds_write_b128 v4, v[72:75] offset:53376
    ds_write_b128 v5, v[76:79] offset:53376
    s_waitcnt lgkmcnt(0)
    s_barrier
    s_endpgm
L_MFMA:
    v_mov_b32 v11, 0
    v_bfe_u32 v4, v0, 3, 1
    v_lshlrev_b32 v4, 10, v4
    v_lshrrev_b32 v5, 4, v0
    v_lshl_add_u32 v4, v5, 7, v4
    v_and_b32 v5, 7, v0
    v_lshl_add_u32 v4, v5, 4, v4
    s_lshl_b32 s60, s31, 5
    s_add_u32 s60, s60, s32
    s_lshl_b32 s60, s60, 2
    s_and_b32 s61, s30, 3
    s_add_u32 s60, s60, s61
    s_lshl_b32 s60, s60, 11
    s_waitcnt lgkmcnt(0)
    s_mov_b32 s44, s4
    s_mov_b32 s45, s5
    s_mov_b32 s46, 2097152
    s_mov_b32 s47, 0x20000
    s_mov_b32 s40, s28
    s_mov_b32 s41, s29
    s_mov_b32 s42, 15728640
    s_mov_b32 s43, 0x20000
    s_cmp_lg_u32 s2, 0
    s_cbranch_scc1 L_NOPR0
    s_cmp_lg_u32 s30, 1
    s_cbranch_scc1 L_NOPR0
    buffer_load_dword v90, v11, s[40:43], 0 offen sc1
L_NOPR0:
    buffer_load_dwordx4 v[64:67], v4, s[44:47], s60 offen offset:0
    buffer_load_dwordx4 v[68:71], v4, s[44:47], s60 offen offset:512
    s_mov_b32 s52, s14
    s_mov_b32 s53, s15
    s_mov_b32 s54, 1024
    s_mov_b32 s55, 0x20000
    s_lshl_b32 s61, s2, 2
    s_and_b32 s62, s30, 2
    s_add_u32 s61, s61, s62
    buffer_load_ushort v14, v11, s[52:55], s61 offen
    v_and_b32 v1, 15, v0
    v_lshrrev_b32 v2, 4, v0
    v_lshrrev_b32 v3, 1, v1
    v_xor_b32 v3, v3, v2
    v_lshlrev_b32 v3, 4, v3
    v_lshl_add_u32 v3, v1, 7, v3
    s_lshl_b32 s60, s30, 13
    s_add_u32 s60, s60, 16384
    v_add_u32 v16, s60, v3
    v_xor_b32 v17, 64, v16
    v_lshrrev_b32 v2, 4, v0
    v_bfe_u32 v3, v0, 2, 2
    v_and_b32 v4, 2, v3
    v_and_b32 v5, 1, v2
    v_lshl_add_u32 v4, v5, 2, v4
    v_bfe_u32 v5, v0, 1, 1
    v_add_u32 v4, v4, v5
    v_lshlrev_b32 v4, 4, v4
    v_and_b32 v5, 1, v0
    v_lshl_add_u32 v4, v5, 3, v4
    v_lshl_add_u32 v3, v2, 3, v3
    v_lshl_add_u32 v20, v3, 7, v4
    v_add_u32 v20, 49152, v20
    v_xor_b32 v21, 32, v20
    v_xor_b32 v22, 64, v20
    v_xor_b32 v23, 96, v20
    v_add_u32 v18, 98304, v16
    v_add_u32 v19, 98304, v17
    v_add_u32 v24, 98304, v20
    v_add_u32 v25, 98304, v21
    v_add_u32 v26, 98304, v22
    v_add_u32 v27, 98304, v23
    v_lshlrev_b32 v8, 4, v0
    v_lshlrev_b32 v9, 2, v1
    s_lshl_b32 s60, s30, 8
    v_add_u32 v10, s60, v9
    v_lshrrev_b32 v9, 4, v0
    v_mul_u32_u24 v9, 1152, v9
    v_lshl_add_u32 v9, v1, 3, v9
    v_mov_b32 v11, 0
    v_and_b32 v1, 15, v0
    v_lshrrev_b32 v2, 4, v0
    v_add_u32 v3, 1, v1
    v_lshrrev_b32 v3, 1, v3
    v_lshl_add_u32 v3, v2, 2, v3
    v_lshlrev_b32 v3, 2, v3
    v_and_b32 v4, 1, v1
    v_xor_b32 v4, 1, v4
    v_mul_u32_u24 v4, 41152, v4
    v_add_u32 v3, v3, v4
    s_lshr_b32 s61, s30, 1
    s_mul_i32 s60, s61, 4160
    v_add_u32 v3, s60, v3
    s_and_b32 s60, s30, 1
    s_lshl_b32 s60, s60, 8
    s_add_u32 s60, s60, 6144
    v_add_u32 v32, s60, v3
    v_lshlrev_b32 v3, 5, v1
    v_lshlrev_b32 v4, 4, v2
    v_sub_u32 v3, v4, v3
    s_mul_i32 s61, s61, 4608
    s_add_u32 s60, s60, s61
    s_add_u32 s60, s60, 49952
    v_add_u32 v33, s60, v3
    v_lshlrev_b32 v3, 3, v2
    v_add_u32 v3, v3, v1
    v_sub_u32 v7, 15, v3
    v_mov_b32 v15, 1
    s_mov_b32 s65, 0x01000100
    s_lshl_b32 s64, s34, 2
    s_add_u32 s64, s64, s30
    s_mul_i32 s64, s64, 28
    s_add_u32 s64, s64, s35
    s_lshl_b32 s64, s64, 12
    s_add_u32 s64, s64, 7340032
    s_lshl_b32 s76, s34, 2
    s_add_u32 s76, s76, s30
    s_lshl_b32 s76, s76, 5
    s_mul_i32 s61, s35, 37
    s_lshr_b32 s61, s61, 8
    s_add_u32 s76, s76, s61
    s_add_u32 s76, s76, s35
    s_lshl_b32 s76, s76, 7
    s_add_u32 s76, s76, 655360
    s_cmp_lg_u32 s2, 0
    s_cbranch_scc1 L_NOPROD
    s_cmp_lg_u32 s30, 1
    s_cbranch_scc1 L_NOPROD
    s_mov_b32 s56, s26
    s_mov_b32 s57, s27
    s_mov_b32 s58, 256
    s_mov_b32 s59, 0x20000
    s_waitcnt vmcnt(3)
    s_mov_b32 s60, 0x9e3779b1
    v_add_u32 v90, 1, v90
    v_mov_b32 v3, 1
    v_mul_lo_u32 v2, v90, s60
    v_xor_b32 v2, 0x85ebca6a, v2
    s_mov_b64 exec, 1
    buffer_store_dwordx2 v[2:3], v11, s[56:59], 0 offen sc1
    buffer_store_dword v90, v11, s[40:43], 0 offen sc1
    s_mov_b64 exec, -1
L_NOPROD:
    v_mov_b32 v84, 0x3f803f80
    v_mov_b32 v85, 0x3f803f80
    v_mov_b32 v86, 0x3f803f80
    v_mov_b32 v87, 0x3f803f80
    v_lshrrev_b32 v88, 3, v0
    s_lshl_b32 s60, s30, 3
    v_add_u32 v88, s60, v88
    s_waitcnt vmcnt(2)
    s_cmp_lg_u32 s2, 0
    s_cbranch_scc1 L_STW
    s_cmp_eq_u32 s30, 1
    s_cbranch_scc1 L_STG
L_STW:
    s_waitcnt vmcnt(0)
L_STG:
    v_mfma_f32_16x16x32_bf16 v[72:75], v[64:67], v[64:67], 0
    v_mfma_f32_16x16x32_bf16 v[76:79], v[64:67], v[84:87], 0
    v_mfma_f32_16x16x32_bf16 v[72:75], v[68:71], v[68:71], v[72:75]
    v_mfma_f32_16x16x32_bf16 v[76:79], v[68:71], v[84:87], v[76:79]
    v_lshrrev_b32 v80, 4, v0
    v_mul_u32_u24 v80, 20, v80
    v_sub_u32 v80, v0, v80
    v_mov_b32 v81, 0
    v_cmp_eq_u32 vcc, 0, v80
    s_nop 1
    v_cndmask_b32 v81, v81, v72, vcc
    v_cmp_eq_u32 vcc, 1, v80
    s_nop 1
    v_cndmask_b32 v81, v81, v73, vcc
    v_cmp_eq_u32 vcc, 2, v80
    s_nop 1
    v_cndmask_b32 v81, v81, v74, vcc
    v_cmp_eq_u32 vcc, 3, v80
    s_nop 1
    v_cndmask_b32 v81, v81, v75, vcc
    v_add_f32 v76, v76, v77
    v_add_f32 v78, v78, v79
    v_add_f32_dpp v81, v81, v81 quad_perm:[1,0,3,2] row_mask:0xf bank_mask:0xf
    s_nop 1
    v_add_f32_dpp v81, v81, v81 quad_perm:[2,3,0,1] row_mask:0xf bank_mask:0xf
    s_nop 1
    v_add_f32_dpp v81, v81, v81 row_half_mirror row_mask:0xf bank_mask:0xf
    s_nop 1
    v_add_f32_dpp v81, v81, v81 row_mirror row_mask:0xf bank_mask:0xf
    v_add_f32 v76, v76, v78
    v_mov_b32 v72, v81
    v_mov_b32 v77, v76
    s_nop 0
    v_permlane16_swap_b32 v72, v81
    v_permlane16_swap_b32 v76, v77
    v_add_f32 v72, v72, v81
    v_add_f32 v76, v76, v77
    v_mul_f32 v76, 0x3b000000, v76
    v_mul_f32 v73, v76, v76
    v_mul_f32 v72, 0x3b000000, v72
    v_sub_f32 v72, v72, v73
    v_max_f32 v72, 0, v72
    v_cvt_pk_bf16_f32 v72, v72, v72
    v_lshlrev_b32 v72, 16, v72
    v_add_f32 v72, 0x3727c5ac, v72
    v_cvt_pk_bf16_f32 v72, v72, v72
    v_lshlrev_b32 v72, 16, v72
    v_sqrt_f32 v72, v72
    v_lshrrev_b32 v73, 2, v0
    v_cvt_pk_bf16_f32 v74, v76, v72
    s_mov_b32 exec_lo, 1
    s_mov_b32 exec_hi, 1
    ds_write_b32 v88, v74 offset:1408
    s_mov_b64 exec, -1
    s_waitcnt lgkmcnt(0)
    s_barrier
    ds_read_b128 v[64:67], v16 offset:49152
    ds_read_b64_tr_b16 v[40:41], v20 offset:49152
    ds_read_b64_tr_b16 v[42:43], v20 offset:49664
    ds_read_b128 v[68:71], v17 offset:49152
    ds_read_b64_tr_b16 v[44:45], v20 offset:53248
    ds_read_b64_tr_b16 v[46:47], v20 offset:53760
    ds_read_b128 v[72:75], v16 offset:51200
    ds_read_b128 v[76:79], v17 offset:51200
    ds_read_b128 v[80:83], v16 offset:53248
    ds_read_b128 v[84:87], v17 offset:53248
    ds_read_b128 v[88:91], v16 offset:55296
    ds_read_b128 v[92:95], v17 offset:55296
    ds_read_b64_tr_b16 v[48:49], v20 offset:57344
    ds_read_b64_tr_b16 v[50:51], v20 offset:57856
    ds_read_b64_tr_b16 v[52:53], v20 offset:61440
    ds_read_b64_tr_b16 v[54:55], v20 offset:61952
    s_waitcnt lgkmcnt(13)
    v_mfma_f32_16x16x32_bf16 v[128:131], v[40:43], v[64:67], 0
    ds_read_b64_tr_b16 v[56:57], v21 offset:49152
    s_waitcnt lgkmcnt(11)
    v_mfma_f32_16x16x32_bf16 v[128:131], v[44:47], v[68:71], v[128:131]
    ds_read_b64_tr_b16 v[58:59], v21 offset:49664
    s_waitcnt lgkmcnt(10)
    v_mfma_f32_16x16x32_bf16 v[160:163], v[44:47], v[76:79], 0
    ds_read_b64_tr_b16 v[60:61], v21 offset:53248
    v_mfma_f32_16x16x32_bf16 v[160:163], v[40:43], v[72:75], v[160:163]
    ds_read_b64_tr_b16 v[62:63], v21 offset:53760
    s_waitcnt lgkmcnt(11)
    v_mfma_f32_16x16x32_bf16 v[192:195], v[40:43], v[80:83], 0
    s_waitcnt lgkmcnt(10)
    v_mfma_f32_16x16x32_bf16 v[192:195], v[44:47], v[84:87], v[192:195]
    s_waitcnt lgkmcnt(8)
    v_mfma_f32_16x16x32_bf16 v[224:227], v[44:47], v[92:95], 0
    v_mfma_f32_16x16x32_bf16 v[224:227], v[40:43], v[88:91], v[224:227]
    s_waitcnt lgkmcnt(6)
    v_mfma_f32_16x16x32_bf16 v[228:231], v[48:51], v[88:91], 0
    ds_read_b64_tr_b16 v[40:41], v21 offset:57344
    s_waitcnt lgkmcnt(5)
    v_mfma_f32_16x16x32_bf16 v[228:231], v[52:55], v[92:95], v[228:231]
    ds_read_b64_tr_b16 v[42:43], v21 offset:57856
    v_mfma_f32_16x16x32_bf16 v[196:199], v[52:55], v[84:87], 0
    ds_read_b64_tr_b16 v[44:45], v21 offset:61440
    v_mfma_f32_16x16x32_bf16 v[196:199], v[48:51], v[80:83], v[196:199]
    ds_read_b64_tr_b16 v[46:47], v21 offset:61952
    v_mfma_f32_16x16x32_bf16 v[164:167], v[48:51], v[72:75], 0
    v_mfma_f32_16x16x32_bf16 v[164:167], v[52:55], v[76:79], v[164:167]
    v_mfma_f32_16x16x32_bf16 v[132:135], v[52:55], v[68:71], 0
    v_mfma_f32_16x16x32_bf16 v[132:135], v[48:51], v[64:67], v[132:135]
    s_waitcnt lgkmcnt(6)
    v_mfma_f32_16x16x32_bf16 v[136:139], v[56:59], v[64:67], 0
    ds_read_b64_tr_b16 v[48:49], v22 offset:49152
    s_waitcnt lgkmcnt(5)
    v_mfma_f32_16x16x32_bf16 v[136:139], v[60:63], v[68:71], v[136:139]
    ds_read_b64_tr_b16 v[50:51], v22 offset:49664
    v_mfma_f32_16x16x32_bf16 v[168:171], v[60:63], v[76:79], 0
    ds_read_b64_tr_b16 v[52:53], v22 offset:53248
    v_mfma_f32_16x16x32_bf16 v[168:171], v[56:59], v[72:75], v[168:171]
    ds_read_b64_tr_b16 v[54:55], v22 offset:53760
    v_mfma_f32_16x16x32_bf16 v[200:203], v[56:59], v[80:83], 0
    v_mfma_f32_16x16x32_bf16 v[200:203], v[60:63], v[84:87], v[200:203]
    v_mfma_f32_16x16x32_bf16 v[232:235], v[60:63], v[92:95], 0
    v_mfma_f32_16x16x32_bf16 v[232:235], v[56:59], v[88:91], v[232:235]
    s_waitcnt lgkmcnt(6)
    v_mfma_f32_16x16x32_bf16 v[236:239], v[40:43], v[88:91], 0
    ds_read_b64_tr_b16 v[56:57], v22 offset:57344
    s_waitcnt lgkmcnt(5)
    v_mfma_f32_16x16x32_bf16 v[236:239], v[44:47], v[92:95], v[236:239]
    ds_read_b64_tr_b16 v[58:59], v22 offset:57856
    v_mfma_f32_16x16x32_bf16 v[204:207], v[44:47], v[84:87], 0
    ds_read_b64_tr_b16 v[60:61], v22 offset:61440
    v_mfma_f32_16x16x32_bf16 v[204:207], v[40:43], v[80:83], v[204:207]
    ds_read_b64_tr_b16 v[62:63], v22 offset:61952
    v_mfma_f32_16x16x32_bf16 v[172:175], v[40:43], v[72:75], 0
    v_mfma_f32_16x16x32_bf16 v[172:175], v[44:47], v[76:79], v[172:175]
    v_mfma_f32_16x16x32_bf16 v[140:143], v[44:47], v[68:71], 0
    v_mfma_f32_16x16x32_bf16 v[140:143], v[40:43], v[64:67], v[140:143]
    s_waitcnt lgkmcnt(6)
    v_mfma_f32_16x16x32_bf16 v[144:147], v[48:51], v[64:67], 0
    ds_read_b64_tr_b16 v[40:41], v23 offset:49152
    s_waitcnt lgkmcnt(5)
    v_mfma_f32_16x16x32_bf16 v[144:147], v[52:55], v[68:71], v[144:147]
    ds_read_b64_tr_b16 v[42:43], v23 offset:49664
    v_mfma_f32_16x16x32_bf16 v[176:179], v[52:55], v[76:79], 0
    ds_read_b64_tr_b16 v[44:45], v23 offset:53248
    v_mfma_f32_16x16x32_bf16 v[176:179], v[48:51], v[72:75], v[176:179]
    ds_read_b64_tr_b16 v[46:47], v23 offset:53760
    v_mfma_f32_16x16x32_bf16 v[208:211], v[48:51], v[80:83], 0
    v_mfma_f32_16x16x32_bf16 v[208:211], v[52:55], v[84:87], v[208:211]
    v_mfma_f32_16x16x32_bf16 v[240:243], v[52:55], v[92:95], 0
    v_mfma_f32_16x16x32_bf16 v[240:243], v[48:51], v[88:91], v[240:243]
    s_waitcnt lgkmcnt(6)
    v_mfma_f32_16x16x32_bf16 v[244:247], v[56:59], v[88:91], 0
    ds_read_b64_tr_b16 v[48:49], v23 offset:57344
    ds_read_b64_tr_b16 v[50:51], v23 offset:57856
    s_waitcnt lgkmcnt(6)
    v_mfma_f32_16x16x32_bf16 v[244:247], v[60:63], v[92:95], v[244:247]
    ds_read_b64_tr_b16 v[52:53], v23 offset:61440
    ds_read_b64_tr_b16 v[54:55], v23 offset:61952
    v_mfma_f32_16x16x32_bf16 v[212:215], v[60:63], v[84:87], 0
    v_mfma_f32_16x16x32_bf16 v[212:215], v[56:59], v[80:83], v[212:215]
    v_mfma_f32_16x16x32_bf16 v[180:183], v[56:59], v[72:75], 0
    v_mfma_f32_16x16x32_bf16 v[180:183], v[60:63], v[76:79], v[180:183]
    v_mfma_f32_16x16x32_bf16 v[148:151], v[60:63], v[68:71], 0
    v_mfma_f32_16x16x32_bf16 v[148:151], v[56:59], v[64:67], v[148:151]
    s_waitcnt lgkmcnt(6)
    v_mfma_f32_16x16x32_bf16 v[152:155], v[40:43], v[64:67], 0
    s_waitcnt lgkmcnt(0)
    s_barrier
    ds_read_b128 v[96:99], v16 offset:0
    ds_read_b64_tr_b16 v[56:57], v20 offset:0
    v_mfma_f32_16x16x32_bf16 v[152:155], v[44:47], v[68:71], v[152:155]
    ds_read_b64_tr_b16 v[58:59], v20 offset:512
    ds_read_b128 v[100:103], v17 offset:0
    v_mfma_f32_16x16x32_bf16 v[184:187], v[44:47], v[76:79], 0
    ds_read_b64_tr_b16 v[60:61], v20 offset:4096
    ds_read_b64_tr_b16 v[62:63], v20 offset:4608
    v_mfma_f32_16x16x32_bf16 v[184:187], v[40:43], v[72:75], v[184:187]
    ds_read_b128 v[104:107], v16 offset:2048
    ds_read_b128 v[108:111], v17 offset:2048
    v_mfma_f32_16x16x32_bf16 v[216:219], v[40:43], v[80:83], 0
    ds_read_b128 v[112:115], v16 offset:4096
    ds_read_b128 v[116:119], v17 offset:4096
    v_mfma_f32_16x16x32_bf16 v[216:219], v[44:47], v[84:87], v[216:219]
    ds_read_b128 v[120:123], v16 offset:6144
    ds_read_b128 v[124:127], v17 offset:6144
    v_mfma_f32_16x16x32_bf16 v[248:251], v[44:47], v[92:95], 0
    v_mfma_f32_16x16x32_bf16 v[248:251], v[40:43], v[88:91], v[248:251]
    v_mfma_f32_16x16x32_bf16 v[252:255], v[48:51], v[88:91], 0
    ds_read_b64_tr_b16 v[40:41], v20 offset:8192
    ds_read_b64_tr_b16 v[42:43], v20 offset:8704
    v_mfma_f32_16x16x32_bf16 v[252:255], v[52:55], v[92:95], v[252:255]
    ds_read_b64_tr_b16 v[44:45], v20 offset:12288
    ds_read_b64_tr_b16 v[46:47], v20 offset:12800
    v_mfma_f32_16x16x32_bf16 v[220:223], v[52:55], v[84:87], 0
    v_mfma_f32_16x16x32_bf16 v[220:223], v[48:51], v[80:83], v[220:223]
    v_mfma_f32_16x16x32_bf16 v[188:191], v[48:51], v[72:75], 0
    v_mfma_f32_16x16x32_bf16 v[188:191], v[52:55], v[76:79], v[188:191]
    v_mfma_f32_16x16x32_bf16 v[156:159], v[52:55], v[68:71], 0
    v_mfma_f32_16x16x32_bf16 v[156:159], v[48:51], v[64:67], v[156:159]
    s_waitcnt lgkmcnt(13)
    v_mfma_f32_16x16x32_bf16 v[128:131], v[56:59], v[96:99], v[128:131]
    ds_read_b64_tr_b16 v[48:49], v21 offset:0
    s_waitcnt lgkmcnt(11)
    v_mfma_f32_16x16x32_bf16 v[128:131], v[60:63], v[100:103], v[128:131]
    ds_read_b64_tr_b16 v[50:51], v21 offset:512
    s_waitcnt lgkmcnt(10)
    v_mfma_f32_16x16x32_bf16 v[160:163], v[60:63], v[108:111], v[160:163]
    ds_read_b64_tr_b16 v[52:53], v21 offset:4096
    v_mfma_f32_16x16x32_bf16 v[160:163], v[56:59], v[104:107], v[160:163]
    ds_read_b64_tr_b16 v[54:55], v21 offset:4608
    s_waitcnt lgkmcnt(11)
    v_mfma_f32_16x16x32_bf16 v[192:195], v[56:59], v[112:115], v[192:195]
    s_waitcnt lgkmcnt(10)
    v_mfma_f32_16x16x32_bf16 v[192:195], v[60:63], v[116:119], v[192:195]
    s_waitcnt lgkmcnt(8)
    v_mfma_f32_16x16x32_bf16 v[224:227], v[60:63], v[124:127], v[224:227]
    v_mfma_f32_16x16x32_bf16 v[224:227], v[56:59], v[120:123], v[224:227]
    s_waitcnt lgkmcnt(6)
    v_mfma_f32_16x16x32_bf16 v[228:231], v[40:43], v[120:123], v[228:231]
    ds_read_b64_tr_b16 v[56:57], v21 offset:8192
    s_waitcnt lgkmcnt(5)
    v_mfma_f32_16x16x32_bf16 v[228:231], v[44:47], v[124:127], v[228:231]
    ds_read_b64_tr_b16 v[58:59], v21 offset:8704
    v_mfma_f32_16x16x32_bf16 v[196:199], v[44:47], v[116:119], v[196:199]
    ds_read_b64_tr_b16 v[60:61], v21 offset:12288
    v_mfma_f32_16x16x32_bf16 v[196:199], v[40:43], v[112:115], v[196:199]
    ds_read_b64_tr_b16 v[62:63], v21 offset:12800
    v_mfma_f32_16x16x32_bf16 v[164:167], v[40:43], v[104:107], v[164:167]
    v_mfma_f32_16x16x32_bf16 v[164:167], v[44:47], v[108:111], v[164:167]
    v_mfma_f32_16x16x32_bf16 v[132:135], v[44:47], v[100:103], v[132:135]
    v_mfma_f32_16x16x32_bf16 v[132:135], v[40:43], v[96:99], v[132:135]
    s_waitcnt lgkmcnt(6)
    v_mfma_f32_16x16x32_bf16 v[136:139], v[48:51], v[96:99], v[136:139]
    ds_read_b64_tr_b16 v[40:41], v22 offset:0
    s_waitcnt lgkmcnt(5)
    v_mfma_f32_16x16x32_bf16 v[136:139], v[52:55], v[100:103], v[136:139]
    ds_read_b64_tr_b16 v[42:43], v22 offset:512
    v_mfma_f32_16x16x32_bf16 v[168:171], v[52:55], v[108:111], v[168:171]
    ds_read_b64_tr_b16 v[44:45], v22 offset:4096
    v_mfma_f32_16x16x32_bf16 v[168:171], v[48:51], v[104:107], v[168:171]
    ds_read_b64_tr_b16 v[46:47], v22 offset:4608
    v_mfma_f32_16x16x32_bf16 v[200:203], v[48:51], v[112:115], v[200:203]
    v_mfma_f32_16x16x32_bf16 v[200:203], v[52:55], v[116:119], v[200:203]
    v_mfma_f32_16x16x32_bf16 v[232:235], v[52:55], v[124:127], v[232:235]
    v_mfma_f32_16x16x32_bf16 v[232:235], v[48:51], v[120:123], v[232:235]
    s_waitcnt lgkmcnt(6)
    v_mfma_f32_16x16x32_bf16 v[236:239], v[56:59], v[120:123], v[236:239]
    ds_read_b64_tr_b16 v[48:49], v22 offset:8192
    s_waitcnt lgkmcnt(5)
    v_mfma_f32_16x16x32_bf16 v[236:239], v[60:63], v[124:127], v[236:239]
    ds_read_b64_tr_b16 v[50:51], v22 offset:8704
    v_mfma_f32_16x16x32_bf16 v[204:207], v[60:63], v[116:119], v[204:207]
    ds_read_b64_tr_b16 v[52:53], v22 offset:12288
    v_mfma_f32_16x16x32_bf16 v[204:207], v[56:59], v[112:115], v[204:207]
    ds_read_b64_tr_b16 v[54:55], v22 offset:12800
    v_mfma_f32_16x16x32_bf16 v[172:175], v[56:59], v[104:107], v[172:175]
    v_mfma_f32_16x16x32_bf16 v[172:175], v[60:63], v[108:111], v[172:175]
    v_mfma_f32_16x16x32_bf16 v[140:143], v[60:63], v[100:103], v[140:143]
    v_mfma_f32_16x16x32_bf16 v[140:143], v[56:59], v[96:99], v[140:143]
    s_waitcnt lgkmcnt(6)
    v_mfma_f32_16x16x32_bf16 v[144:147], v[40:43], v[96:99], v[144:147]
    ds_read_b64_tr_b16 v[56:57], v23 offset:0
    s_waitcnt lgkmcnt(5)
    v_mfma_f32_16x16x32_bf16 v[144:147], v[44:47], v[100:103], v[144:147]
    ds_read_b64_tr_b16 v[58:59], v23 offset:512
    v_mfma_f32_16x16x32_bf16 v[176:179], v[44:47], v[108:111], v[176:179]
    ds_read_b64_tr_b16 v[60:61], v23 offset:4096
    v_mfma_f32_16x16x32_bf16 v[176:179], v[40:43], v[104:107], v[176:179]
    ds_read_b64_tr_b16 v[62:63], v23 offset:4608
    v_mfma_f32_16x16x32_bf16 v[208:211], v[40:43], v[112:115], v[208:211]
    v_mfma_f32_16x16x32_bf16 v[208:211], v[44:47], v[116:119], v[208:211]
    v_mfma_f32_16x16x32_bf16 v[240:243], v[44:47], v[124:127], v[240:243]
    v_mfma_f32_16x16x32_bf16 v[240:243], v[40:43], v[120:123], v[240:243]
    s_waitcnt lgkmcnt(6)
    v_mfma_f32_16x16x32_bf16 v[244:247], v[48:51], v[120:123], v[244:247]
    ds_read_b64_tr_b16 v[40:41], v23 offset:8192
    ds_read_b64_tr_b16 v[42:43], v23 offset:8704
    s_waitcnt lgkmcnt(6)
    v_mfma_f32_16x16x32_bf16 v[244:247], v[52:55], v[124:127], v[244:247]
    ds_read_b64_tr_b16 v[44:45], v23 offset:12288
    ds_read_b64_tr_b16 v[46:47], v23 offset:12800
    v_mfma_f32_16x16x32_bf16 v[212:215], v[52:55], v[116:119], v[212:215]
    v_mfma_f32_16x16x32_bf16 v[212:215], v[48:51], v[112:115], v[212:215]
    v_mfma_f32_16x16x32_bf16 v[180:183], v[48:51], v[104:107], v[180:183]
    v_mfma_f32_16x16x32_bf16 v[180:183], v[52:55], v[108:111], v[180:183]
    v_mfma_f32_16x16x32_bf16 v[148:151], v[52:55], v[100:103], v[148:151]
    v_mfma_f32_16x16x32_bf16 v[148:151], v[48:51], v[96:99], v[148:151]
    s_waitcnt lgkmcnt(6)
    v_mfma_f32_16x16x32_bf16 v[152:155], v[56:59], v[96:99], v[152:155]
    s_waitcnt lgkmcnt(0)
    s_barrier
    ds_read_b128 v[64:67], v18 offset:0
    ds_read_b64_tr_b16 v[48:49], v24 offset:0
    v_mfma_f32_16x16x32_bf16 v[152:155], v[60:63], v[100:103], v[152:155]
    ds_read_b64_tr_b16 v[50:51], v24 offset:512
    ds_read_b128 v[68:71], v19 offset:0
    v_mfma_f32_16x16x32_bf16 v[184:187], v[60:63], v[108:111], v[184:187]
    ds_read_b64_tr_b16 v[52:53], v24 offset:4096
    ds_read_b64_tr_b16 v[54:55], v24 offset:4608
    v_mfma_f32_16x16x32_bf16 v[184:187], v[56:59], v[104:107], v[184:187]
    ds_read_b128 v[72:75], v18 offset:2048
    ds_read_b128 v[76:79], v19 offset:2048
    v_mfma_f32_16x16x32_bf16 v[216:219], v[56:59], v[112:115], v[216:219]
    ds_read_b128 v[80:83], v18 offset:4096
    ds_read_b128 v[84:87], v19 offset:4096
    v_mfma_f32_16x16x32_bf16 v[216:219], v[60:63], v[116:119], v[216:219]
    ds_read_b128 v[88:91], v18 offset:6144
    ds_read_b128 v[92:95], v19 offset:6144
    v_mfma_f32_16x16x32_bf16 v[248:251], v[60:63], v[124:127], v[248:251]
    v_mfma_f32_16x16x32_bf16 v[248:251], v[56:59], v[120:123], v[248:251]
    v_mfma_f32_16x16x32_bf16 v[252:255], v[40:43], v[120:123], v[252:255]
    ds_read_b64_tr_b16 v[56:57], v24 offset:8192
    ds_read_b64_tr_b16 v[58:59], v24 offset:8704
    v_mfma_f32_16x16x32_bf16 v[252:255], v[44:47], v[124:127], v[252:255]
    ds_read_b64_tr_b16 v[60:61], v24 offset:12288
    ds_read_b64_tr_b16 v[62:63], v24 offset:12800
    v_mfma_f32_16x16x32_bf16 v[220:223], v[44:47], v[116:119], v[220:223]
    v_mfma_f32_16x16x32_bf16 v[220:223], v[40:43], v[112:115], v[220:223]
    v_mfma_f32_16x16x32_bf16 v[188:191], v[40:43], v[104:107], v[188:191]
    v_mfma_f32_16x16x32_bf16 v[188:191], v[44:47], v[108:111], v[188:191]
    v_mfma_f32_16x16x32_bf16 v[156:159], v[44:47], v[100:103], v[156:159]
    v_mfma_f32_16x16x32_bf16 v[156:159], v[40:43], v[96:99], v[156:159]
    s_waitcnt lgkmcnt(13)
    v_mfma_f32_16x16x32_bf16 v[128:131], v[48:51], v[64:67], v[128:131]
    ds_read_b64_tr_b16 v[40:41], v25 offset:0
    s_waitcnt lgkmcnt(11)
    v_mfma_f32_16x16x32_bf16 v[128:131], v[52:55], v[68:71], v[128:131]
    ds_read_b64_tr_b16 v[42:43], v25 offset:512
    s_waitcnt lgkmcnt(10)
    v_mfma_f32_16x16x32_bf16 v[160:163], v[52:55], v[76:79], v[160:163]
    ds_read_b64_tr_b16 v[44:45], v25 offset:4096
    v_mfma_f32_16x16x32_bf16 v[160:163], v[48:51], v[72:75], v[160:163]
    ds_read_b64_tr_b16 v[46:47], v25 offset:4608
    s_waitcnt lgkmcnt(11)
    v_mfma_f32_16x16x32_bf16 v[192:195], v[48:51], v[80:83], v[192:195]
    s_waitcnt lgkmcnt(10)
    v_mfma_f32_16x16x32_bf16 v[192:195], v[52:55], v[84:87], v[192:195]
    s_waitcnt lgkmcnt(8)
    v_mfma_f32_16x16x32_bf16 v[224:227], v[52:55], v[92:95], v[224:227]
    v_mfma_f32_16x16x32_bf16 v[224:227], v[48:51], v[88:91], v[224:227]
    s_waitcnt lgkmcnt(6)
    v_mfma_f32_16x16x32_bf16 v[228:231], v[56:59], v[88:91], v[228:231]
    ds_read_b64_tr_b16 v[48:49], v25 offset:8192
    s_waitcnt lgkmcnt(5)
    v_mfma_f32_16x16x32_bf16 v[228:231], v[60:63], v[92:95], v[228:231]
    ds_read_b64_tr_b16 v[50:51], v25 offset:8704
    v_mfma_f32_16x16x32_bf16 v[196:199], v[60:63], v[84:87], v[196:199]
    ds_read_b64_tr_b16 v[52:53], v25 offset:12288
    v_mfma_f32_16x16x32_bf16 v[196:199], v[56:59], v[80:83], v[196:199]
    ds_read_b64_tr_b16 v[54:55], v25 offset:12800
    v_mfma_f32_16x16x32_bf16 v[164:167], v[56:59], v[72:75], v[164:167]
    v_mfma_f32_16x16x32_bf16 v[164:167], v[60:63], v[76:79], v[164:167]
    v_mfma_f32_16x16x32_bf16 v[132:135], v[60:63], v[68:71], v[132:135]
    v_mfma_f32_16x16x32_bf16 v[132:135], v[56:59], v[64:67], v[132:135]
    s_waitcnt lgkmcnt(6)
    v_mfma_f32_16x16x32_bf16 v[136:139], v[40:43], v[64:67], v[136:139]
    ds_read_b64_tr_b16 v[56:57], v26 offset:0
    s_waitcnt lgkmcnt(5)
    v_mfma_f32_16x16x32_bf16 v[136:139], v[44:47], v[68:71], v[136:139]
    ds_read_b64_tr_b16 v[58:59], v26 offset:512
    v_mfma_f32_16x16x32_bf16 v[168:171], v[44:47], v[76:79], v[168:171]
    ds_read_b64_tr_b16 v[60:61], v26 offset:4096
    v_mfma_f32_16x16x32_bf16 v[168:171], v[40:43], v[72:75], v[168:171]
    ds_read_b64_tr_b16 v[62:63], v26 offset:4608
    v_mfma_f32_16x16x32_bf16 v[200:203], v[40:43], v[80:83], v[200:203]
    v_mfma_f32_16x16x32_bf16 v[200:203], v[44:47], v[84:87], v[200:203]
    v_mfma_f32_16x16x32_bf16 v[232:235], v[44:47], v[92:95], v[232:235]
    v_mfma_f32_16x16x32_bf16 v[232:235], v[40:43], v[88:91], v[232:235]
    s_waitcnt lgkmcnt(6)
    v_mfma_f32_16x16x32_bf16 v[236:239], v[48:51], v[88:91], v[236:239]
    ds_read_b64_tr_b16 v[40:41], v26 offset:8192
    s_waitcnt lgkmcnt(5)
    v_mfma_f32_16x16x32_bf16 v[236:239], v[52:55], v[92:95], v[236:239]
    ds_read_b64_tr_b16 v[42:43], v26 offset:8704
    v_mfma_f32_16x16x32_bf16 v[204:207], v[52:55], v[84:87], v[204:207]
    ds_read_b64_tr_b16 v[44:45], v26 offset:12288
    v_mfma_f32_16x16x32_bf16 v[204:207], v[48:51], v[80:83], v[204:207]
    ds_read_b64_tr_b16 v[46:47], v26 offset:12800
    v_mfma_f32_16x16x32_bf16 v[172:175], v[48:51], v[72:75], v[172:175]
    v_mfma_f32_16x16x32_bf16 v[172:175], v[52:55], v[76:79], v[172:175]
    v_mfma_f32_16x16x32_bf16 v[140:143], v[52:55], v[68:71], v[140:143]
    v_mfma_f32_16x16x32_bf16 v[140:143], v[48:51], v[64:67], v[140:143]
    s_waitcnt lgkmcnt(6)
    v_mfma_f32_16x16x32_bf16 v[144:147], v[56:59], v[64:67], v[144:147]
    ds_read_b64_tr_b16 v[48:49], v27 offset:0
    s_waitcnt lgkmcnt(5)
    v_mfma_f32_16x16x32_bf16 v[144:147], v[60:63], v[68:71], v[144:147]
    ds_read_b64_tr_b16 v[50:51], v27 offset:512
    v_mfma_f32_16x16x32_bf16 v[176:179], v[60:63], v[76:79], v[176:179]
    ds_read_b64_tr_b16 v[52:53], v27 offset:4096
    v_mfma_f32_16x16x32_bf16 v[176:179], v[56:59], v[72:75], v[176:179]
    ds_read_b64_tr_b16 v[54:55], v27 offset:4608
    v_mfma_f32_16x16x32_bf16 v[208:211], v[56:59], v[80:83], v[208:211]
    v_mfma_f32_16x16x32_bf16 v[208:211], v[60:63], v[84:87], v[208:211]
    v_mfma_f32_16x16x32_bf16 v[240:243], v[60:63], v[92:95], v[240:243]
    v_mfma_f32_16x16x32_bf16 v[240:243], v[56:59], v[88:91], v[240:243]
    s_waitcnt lgkmcnt(6)
    v_mfma_f32_16x16x32_bf16 v[244:247], v[40:43], v[88:91], v[244:247]
    ds_read_b64_tr_b16 v[56:57], v27 offset:8192
    ds_read_b64_tr_b16 v[58:59], v27 offset:8704
    s_waitcnt lgkmcnt(6)
    v_mfma_f32_16x16x32_bf16 v[244:247], v[44:47], v[92:95], v[244:247]
    ds_read_b64_tr_b16 v[60:61], v27 offset:12288
    ds_read_b64_tr_b16 v[62:63], v27 offset:12800
    v_mfma_f32_16x16x32_bf16 v[212:215], v[44:47], v[84:87], v[212:215]
    v_mfma_f32_16x16x32_bf16 v[212:215], v[40:43], v[80:83], v[212:215]
    v_mfma_f32_16x16x32_bf16 v[180:183], v[40:43], v[72:75], v[180:183]
    v_mfma_f32_16x16x32_bf16 v[180:183], v[44:47], v[76:79], v[180:183]
    v_mfma_f32_16x16x32_bf16 v[148:151], v[44:47], v[68:71], v[148:151]
    v_mfma_f32_16x16x32_bf16 v[148:151], v[40:43], v[64:67], v[148:151]
    s_waitcnt lgkmcnt(6)
    v_mfma_f32_16x16x32_bf16 v[152:155], v[48:51], v[64:67], v[152:155]
    s_waitcnt lgkmcnt(0)
    s_waitcnt vmcnt(0)
    s_barrier
    ds_read_b128 v[96:99], v16 offset:49152
    ds_read_b64_tr_b16 v[40:41], v20 offset:49152
    v_mfma_f32_16x16x32_bf16 v[152:155], v[52:55], v[68:71], v[152:155]
    ds_read_b64_tr_b16 v[42:43], v20 offset:49664
    ds_read_b128 v[100:103], v17 offset:49152
    v_mfma_f32_16x16x32_bf16 v[184:187], v[52:55], v[76:79], v[184:187]
    ds_read_b64_tr_b16 v[44:45], v20 offset:53248
    ds_read_b64_tr_b16 v[46:47], v20 offset:53760
    v_mfma_f32_16x16x32_bf16 v[184:187], v[48:51], v[72:75], v[184:187]
    ds_read_b128 v[104:107], v16 offset:51200
    ds_read_b128 v[108:111], v17 offset:51200
    v_mfma_f32_16x16x32_bf16 v[216:219], v[48:51], v[80:83], v[216:219]
    ds_read_b128 v[112:115], v16 offset:53248
    ds_read_b128 v[116:119], v17 offset:53248
    v_mfma_f32_16x16x32_bf16 v[216:219], v[52:55], v[84:87], v[216:219]
    ds_read_b128 v[120:123], v16 offset:55296
    ds_read_b128 v[124:127], v17 offset:55296
    v_mfma_f32_16x16x32_bf16 v[248:251], v[52:55], v[92:95], v[248:251]
    v_mfma_f32_16x16x32_bf16 v[248:251], v[48:51], v[88:91], v[248:251]
    v_mfma_f32_16x16x32_bf16 v[252:255], v[56:59], v[88:91], v[252:255]
    ds_read_b64_tr_b16 v[48:49], v20 offset:57344
    ds_read_b64_tr_b16 v[50:51], v20 offset:57856
    v_mfma_f32_16x16x32_bf16 v[252:255], v[60:63], v[92:95], v[252:255]
    ds_read_b64_tr_b16 v[52:53], v20 offset:61440
    ds_read_b64_tr_b16 v[54:55], v20 offset:61952
    v_mfma_f32_16x16x32_bf16 v[220:223], v[60:63], v[84:87], v[220:223]
    v_mfma_f32_16x16x32_bf16 v[220:223], v[56:59], v[80:83], v[220:223]
    v_mfma_f32_16x16x32_bf16 v[188:191], v[56:59], v[72:75], v[188:191]
    v_mfma_f32_16x16x32_bf16 v[188:191], v[60:63], v[76:79], v[188:191]
    v_mfma_f32_16x16x32_bf16 v[156:159], v[60:63], v[68:71], v[156:159]
    v_mfma_f32_16x16x32_bf16 v[156:159], v[56:59], v[64:67], v[156:159]
    s_waitcnt lgkmcnt(13)
    v_mfma_f32_16x16x32_bf16 v[128:131], v[40:43], v[96:99], v[128:131]
    ds_read_b64_tr_b16 v[56:57], v21 offset:49152
    s_waitcnt lgkmcnt(11)
    v_mfma_f32_16x16x32_bf16 v[128:131], v[44:47], v[100:103], v[128:131]
    ds_read_b64_tr_b16 v[58:59], v21 offset:49664
    s_waitcnt lgkmcnt(10)
    v_mfma_f32_16x16x32_bf16 v[160:163], v[44:47], v[108:111], v[160:163]
    ds_read_b64_tr_b16 v[60:61], v21 offset:53248
    v_mfma_f32_16x16x32_bf16 v[160:163], v[40:43], v[104:107], v[160:163]
    ds_read_b64_tr_b16 v[62:63], v21 offset:53760
    s_waitcnt lgkmcnt(11)
    v_mfma_f32_16x16x32_bf16 v[192:195], v[40:43], v[112:115], v[192:195]
    s_waitcnt lgkmcnt(10)
    v_mfma_f32_16x16x32_bf16 v[192:195], v[44:47], v[116:119], v[192:195]
    s_waitcnt lgkmcnt(8)
    v_mfma_f32_16x16x32_bf16 v[224:227], v[44:47], v[124:127], v[224:227]
    v_mfma_f32_16x16x32_bf16 v[224:227], v[40:43], v[120:123], v[224:227]
    s_waitcnt lgkmcnt(6)
    v_mfma_f32_16x16x32_bf16 v[228:231], v[48:51], v[120:123], v[228:231]
    ds_read_b64_tr_b16 v[40:41], v21 offset:57344
    s_waitcnt lgkmcnt(5)
    v_mfma_f32_16x16x32_bf16 v[228:231], v[52:55], v[124:127], v[228:231]
    ds_read_b64_tr_b16 v[42:43], v21 offset:57856
    v_mfma_f32_16x16x32_bf16 v[196:199], v[52:55], v[116:119], v[196:199]
    ds_read_b64_tr_b16 v[44:45], v21 offset:61440
    v_mfma_f32_16x16x32_bf16 v[196:199], v[48:51], v[112:115], v[196:199]
    ds_read_b64_tr_b16 v[46:47], v21 offset:61952
    v_mfma_f32_16x16x32_bf16 v[164:167], v[48:51], v[104:107], v[164:167]
    v_mfma_f32_16x16x32_bf16 v[164:167], v[52:55], v[108:111], v[164:167]
    v_mfma_f32_16x16x32_bf16 v[132:135], v[52:55], v[100:103], v[132:135]
    v_mfma_f32_16x16x32_bf16 v[132:135], v[48:51], v[96:99], v[132:135]
    s_waitcnt lgkmcnt(6)
    v_mfma_f32_16x16x32_bf16 v[136:139], v[56:59], v[96:99], v[136:139]
    ds_read_b64_tr_b16 v[48:49], v22 offset:49152
    s_waitcnt lgkmcnt(5)
    v_mfma_f32_16x16x32_bf16 v[136:139], v[60:63], v[100:103], v[136:139]
    ds_read_b64_tr_b16 v[50:51], v22 offset:49664
    v_mfma_f32_16x16x32_bf16 v[168:171], v[60:63], v[108:111], v[168:171]
    ds_read_b64_tr_b16 v[52:53], v22 offset:53248
    v_mfma_f32_16x16x32_bf16 v[168:171], v[56:59], v[104:107], v[168:171]
    ds_read_b64_tr_b16 v[54:55], v22 offset:53760
    v_mfma_f32_16x16x32_bf16 v[200:203], v[56:59], v[112:115], v[200:203]
    v_mfma_f32_16x16x32_bf16 v[200:203], v[60:63], v[116:119], v[200:203]
    v_mfma_f32_16x16x32_bf16 v[232:235], v[60:63], v[124:127], v[232:235]
    v_mfma_f32_16x16x32_bf16 v[232:235], v[56:59], v[120:123], v[232:235]
    s_waitcnt lgkmcnt(6)
    v_mfma_f32_16x16x32_bf16 v[236:239], v[40:43], v[120:123], v[236:239]
    ds_read_b64_tr_b16 v[56:57], v22 offset:57344
    s_waitcnt lgkmcnt(5)
    v_mfma_f32_16x16x32_bf16 v[236:239], v[44:47], v[124:127], v[236:239]
    ds_read_b64_tr_b16 v[58:59], v22 offset:57856
    v_mfma_f32_16x16x32_bf16 v[204:207], v[44:47], v[116:119], v[204:207]
    ds_read_b64_tr_b16 v[60:61], v22 offset:61440
    v_mfma_f32_16x16x32_bf16 v[204:207], v[40:43], v[112:115], v[204:207]
    ds_read_b64_tr_b16 v[62:63], v22 offset:61952
    v_mfma_f32_16x16x32_bf16 v[172:175], v[40:43], v[104:107], v[172:175]
    v_mfma_f32_16x16x32_bf16 v[172:175], v[44:47], v[108:111], v[172:175]
    v_mfma_f32_16x16x32_bf16 v[140:143], v[44:47], v[100:103], v[140:143]
    v_mfma_f32_16x16x32_bf16 v[140:143], v[40:43], v[96:99], v[140:143]
    s_waitcnt lgkmcnt(6)
    v_mfma_f32_16x16x32_bf16 v[144:147], v[48:51], v[96:99], v[144:147]
    ds_read_b64_tr_b16 v[40:41], v23 offset:49152
    s_waitcnt lgkmcnt(5)
    v_mfma_f32_16x16x32_bf16 v[144:147], v[52:55], v[100:103], v[144:147]
    ds_read_b64_tr_b16 v[42:43], v23 offset:49664
    v_mfma_f32_16x16x32_bf16 v[176:179], v[52:55], v[108:111], v[176:179]
    ds_read_b64_tr_b16 v[44:45], v23 offset:53248
    v_mfma_f32_16x16x32_bf16 v[176:179], v[48:51], v[104:107], v[176:179]
    ds_read_b64_tr_b16 v[46:47], v23 offset:53760
    v_mfma_f32_16x16x32_bf16 v[208:211], v[48:51], v[112:115], v[208:211]
    v_mfma_f32_16x16x32_bf16 v[208:211], v[52:55], v[116:119], v[208:211]
    v_mfma_f32_16x16x32_bf16 v[240:243], v[52:55], v[124:127], v[240:243]
    v_mfma_f32_16x16x32_bf16 v[240:243], v[48:51], v[120:123], v[240:243]
    s_waitcnt lgkmcnt(6)
    v_mfma_f32_16x16x32_bf16 v[244:247], v[56:59], v[120:123], v[244:247]
    ds_read_b64_tr_b16 v[48:49], v23 offset:57344
    ds_read_b64_tr_b16 v[50:51], v23 offset:57856
    s_waitcnt lgkmcnt(6)
    v_mfma_f32_16x16x32_bf16 v[244:247], v[60:63], v[124:127], v[244:247]
    ds_read_b64_tr_b16 v[52:53], v23 offset:61440
    ds_read_b64_tr_b16 v[54:55], v23 offset:61952
    v_mfma_f32_16x16x32_bf16 v[212:215], v[60:63], v[116:119], v[212:215]
    v_mfma_f32_16x16x32_bf16 v[212:215], v[56:59], v[112:115], v[212:215]
    v_mfma_f32_16x16x32_bf16 v[180:183], v[56:59], v[104:107], v[180:183]
    v_mfma_f32_16x16x32_bf16 v[180:183], v[60:63], v[108:111], v[180:183]
    v_mfma_f32_16x16x32_bf16 v[148:151], v[60:63], v[100:103], v[148:151]
    v_mfma_f32_16x16x32_bf16 v[148:151], v[56:59], v[96:99], v[148:151]
    s_waitcnt lgkmcnt(6)
    v_mfma_f32_16x16x32_bf16 v[152:155], v[40:43], v[96:99], v[152:155]
    s_waitcnt lgkmcnt(0)
    s_barrier
    ds_read_b128 v[64:67], v16 offset:0
    ds_read_b64_tr_b16 v[56:57], v20 offset:0
    v_mfma_f32_16x16x32_bf16 v[152:155], v[44:47], v[100:103], v[152:155]
    ds_read_b64_tr_b16 v[58:59], v20 offset:512
    ds_read_b128 v[68:71], v17 offset:0
    v_mfma_f32_16x16x32_bf16 v[184:187], v[44:47], v[108:111], v[184:187]
    ds_read_b64_tr_b16 v[60:61], v20 offset:4096
    ds_read_b64_tr_b16 v[62:63], v20 offset:4608
    v_mfma_f32_16x16x32_bf16 v[184:187], v[40:43], v[104:107], v[184:187]
    ds_read_b128 v[72:75], v16 offset:2048
    ds_read_b128 v[76:79], v17 offset:2048
    v_mfma_f32_16x16x32_bf16 v[216:219], v[40:43], v[112:115], v[216:219]
    ds_read_b128 v[80:83], v16 offset:4096
    ds_read_b128 v[84:87], v17 offset:4096
    v_mfma_f32_16x16x32_bf16 v[216:219], v[44:47], v[116:119], v[216:219]
    ds_read_b128 v[88:91], v16 offset:6144
    ds_read_b128 v[92:95], v17 offset:6144
    v_mfma_f32_16x16x32_bf16 v[248:251], v[44:47], v[124:127], v[248:251]
    v_mfma_f32_16x16x32_bf16 v[248:251], v[40:43], v[120:123], v[248:251]
    v_mfma_f32_16x16x32_bf16 v[252:255], v[48:51], v[120:123], v[252:255]
    ds_read_b64_tr_b16 v[40:41], v20 offset:8192
    ds_read_b64_tr_b16 v[42:43], v20 offset:8704
    v_mfma_f32_16x16x32_bf16 v[252:255], v[52:55], v[124:127], v[252:255]
    ds_read_b64_tr_b16 v[44:45], v20 offset:12288
    ds_read_b64_tr_b16 v[46:47], v20 offset:12800
    v_mfma_f32_16x16x32_bf16 v[220:223], v[52:55], v[116:119], v[220:223]
    v_mfma_f32_16x16x32_bf16 v[220:223], v[48:51], v[112:115], v[220:223]
    v_mfma_f32_16x16x32_bf16 v[188:191], v[48:51], v[104:107], v[188:191]
    v_mfma_f32_16x16x32_bf16 v[188:191], v[52:55], v[108:111], v[188:191]
    v_mfma_f32_16x16x32_bf16 v[156:159], v[52:55], v[100:103], v[156:159]
    v_mfma_f32_16x16x32_bf16 v[156:159], v[48:51], v[96:99], v[156:159]
    s_waitcnt lgkmcnt(13)
    v_mfma_f32_16x16x32_bf16 v[128:131], v[56:59], v[64:67], v[128:131]
    ds_read_b64_tr_b16 v[48:49], v21 offset:0
    s_waitcnt lgkmcnt(11)
    v_mfma_f32_16x16x32_bf16 v[128:131], v[60:63], v[68:71], v[128:131]
    ds_read_b64_tr_b16 v[50:51], v21 offset:512
    s_waitcnt lgkmcnt(10)
    v_mfma_f32_16x16x32_bf16 v[160:163], v[60:63], v[76:79], v[160:163]
    ds_read_b64_tr_b16 v[52:53], v21 offset:4096
    v_mfma_f32_16x16x32_bf16 v[160:163], v[56:59], v[72:75], v[160:163]
    ds_read_b64_tr_b16 v[54:55], v21 offset:4608
    s_waitcnt lgkmcnt(11)
    v_mfma_f32_16x16x32_bf16 v[192:195], v[56:59], v[80:83], v[192:195]
    s_waitcnt lgkmcnt(10)
    v_mfma_f32_16x16x32_bf16 v[192:195], v[60:63], v[84:87], v[192:195]
    s_waitcnt lgkmcnt(8)
    v_mfma_f32_16x16x32_bf16 v[224:227], v[60:63], v[92:95], v[224:227]
    v_mfma_f32_16x16x32_bf16 v[224:227], v[56:59], v[88:91], v[224:227]
    s_waitcnt lgkmcnt(6)
    v_mfma_f32_16x16x32_bf16 v[228:231], v[40:43], v[88:91], v[228:231]
    ds_read_b64_tr_b16 v[56:57], v21 offset:8192
    s_waitcnt lgkmcnt(5)
    v_mfma_f32_16x16x32_bf16 v[228:231], v[44:47], v[92:95], v[228:231]
    ds_read_b64_tr_b16 v[58:59], v21 offset:8704
    v_mfma_f32_16x16x32_bf16 v[196:199], v[44:47], v[84:87], v[196:199]
    ds_read_b64_tr_b16 v[60:61], v21 offset:12288
    v_mfma_f32_16x16x32_bf16 v[196:199], v[40:43], v[80:83], v[196:199]
    ds_read_b64_tr_b16 v[62:63], v21 offset:12800
    v_mfma_f32_16x16x32_bf16 v[164:167], v[40:43], v[72:75], v[164:167]
    v_mfma_f32_16x16x32_bf16 v[164:167], v[44:47], v[76:79], v[164:167]
    v_mfma_f32_16x16x32_bf16 v[132:135], v[44:47], v[68:71], v[132:135]
    v_mfma_f32_16x16x32_bf16 v[132:135], v[40:43], v[64:67], v[132:135]
    s_waitcnt lgkmcnt(6)
    v_mfma_f32_16x16x32_bf16 v[136:139], v[48:51], v[64:67], v[136:139]
    ds_read_b64_tr_b16 v[40:41], v22 offset:0
    s_waitcnt lgkmcnt(5)
    v_mfma_f32_16x16x32_bf16 v[136:139], v[52:55], v[68:71], v[136:139]
    ds_read_b64_tr_b16 v[42:43], v22 offset:512
    v_mfma_f32_16x16x32_bf16 v[168:171], v[52:55], v[76:79], v[168:171]
    ds_read_b64_tr_b16 v[44:45], v22 offset:4096
    v_mfma_f32_16x16x32_bf16 v[168:171], v[48:51], v[72:75], v[168:171]
    ds_read_b64_tr_b16 v[46:47], v22 offset:4608
    v_mfma_f32_16x16x32_bf16 v[200:203], v[48:51], v[80:83], v[200:203]
    v_mfma_f32_16x16x32_bf16 v[200:203], v[52:55], v[84:87], v[200:203]
    v_mfma_f32_16x16x32_bf16 v[232:235], v[52:55], v[92:95], v[232:235]
    v_mfma_f32_16x16x32_bf16 v[232:235], v[48:51], v[88:91], v[232:235]
    s_waitcnt lgkmcnt(6)
    v_mfma_f32_16x16x32_bf16 v[236:239], v[56:59], v[88:91], v[236:239]
    ds_read_b64_tr_b16 v[48:49], v22 offset:8192
    s_waitcnt lgkmcnt(5)
    v_mfma_f32_16x16x32_bf16 v[236:239], v[60:63], v[92:95], v[236:239]
    ds_read_b64_tr_b16 v[50:51], v22 offset:8704
    v_mfma_f32_16x16x32_bf16 v[204:207], v[60:63], v[84:87], v[204:207]
    ds_read_b64_tr_b16 v[52:53], v22 offset:12288
    v_mfma_f32_16x16x32_bf16 v[204:207], v[56:59], v[80:83], v[204:207]
    ds_read_b64_tr_b16 v[54:55], v22 offset:12800
    v_mfma_f32_16x16x32_bf16 v[172:175], v[56:59], v[72:75], v[172:175]
    v_mfma_f32_16x16x32_bf16 v[172:175], v[60:63], v[76:79], v[172:175]
    v_mfma_f32_16x16x32_bf16 v[140:143], v[60:63], v[68:71], v[140:143]
    v_mfma_f32_16x16x32_bf16 v[140:143], v[56:59], v[64:67], v[140:143]
    s_waitcnt lgkmcnt(6)
    v_mfma_f32_16x16x32_bf16 v[144:147], v[40:43], v[64:67], v[144:147]
    ds_read_b64_tr_b16 v[56:57], v23 offset:0
    s_waitcnt lgkmcnt(5)
    v_mfma_f32_16x16x32_bf16 v[144:147], v[44:47], v[68:71], v[144:147]
    ds_read_b64_tr_b16 v[58:59], v23 offset:512
    v_mfma_f32_16x16x32_bf16 v[176:179], v[44:47], v[76:79], v[176:179]
    ds_read_b64_tr_b16 v[60:61], v23 offset:4096
    v_mfma_f32_16x16x32_bf16 v[176:179], v[40:43], v[72:75], v[176:179]
    ds_read_b64_tr_b16 v[62:63], v23 offset:4608
    v_mfma_f32_16x16x32_bf16 v[208:211], v[40:43], v[80:83], v[208:211]
    v_mfma_f32_16x16x32_bf16 v[208:211], v[44:47], v[84:87], v[208:211]
    v_mfma_f32_16x16x32_bf16 v[240:243], v[44:47], v[92:95], v[240:243]
    v_mfma_f32_16x16x32_bf16 v[240:243], v[40:43], v[88:91], v[240:243]
    s_waitcnt lgkmcnt(6)
    v_mfma_f32_16x16x32_bf16 v[244:247], v[48:51], v[88:91], v[244:247]
    ds_read_b64_tr_b16 v[40:41], v23 offset:8192
    ds_read_b64_tr_b16 v[42:43], v23 offset:8704
    s_waitcnt lgkmcnt(6)
    v_mfma_f32_16x16x32_bf16 v[244:247], v[52:55], v[92:95], v[244:247]
    ds_read_b64_tr_b16 v[44:45], v23 offset:12288
    ds_read_b64_tr_b16 v[46:47], v23 offset:12800
    v_mfma_f32_16x16x32_bf16 v[212:215], v[52:55], v[84:87], v[212:215]
    v_mfma_f32_16x16x32_bf16 v[212:215], v[48:51], v[80:83], v[212:215]
    v_mfma_f32_16x16x32_bf16 v[180:183], v[48:51], v[72:75], v[180:183]
    v_mfma_f32_16x16x32_bf16 v[180:183], v[52:55], v[76:79], v[180:183]
    v_mfma_f32_16x16x32_bf16 v[148:151], v[52:55], v[68:71], v[148:151]
    v_mfma_f32_16x16x32_bf16 v[148:151], v[48:51], v[64:67], v[148:151]
    s_waitcnt lgkmcnt(6)
    v_mfma_f32_16x16x32_bf16 v[152:155], v[56:59], v[64:67], v[152:155]
    s_waitcnt lgkmcnt(0)
    s_barrier
    ds_read_b128 v[96:99], v18 offset:0
    ds_read_b64_tr_b16 v[48:49], v24 offset:0
    v_mfma_f32_16x16x32_bf16 v[152:155], v[60:63], v[68:71], v[152:155]
    ds_read_b64_tr_b16 v[50:51], v24 offset:512
    ds_read_b128 v[100:103], v19 offset:0
    v_mfma_f32_16x16x32_bf16 v[184:187], v[60:63], v[76:79], v[184:187]
    ds_read_b64_tr_b16 v[52:53], v24 offset:4096
    ds_read_b64_tr_b16 v[54:55], v24 offset:4608
    v_mfma_f32_16x16x32_bf16 v[184:187], v[56:59], v[72:75], v[184:187]
    ds_read_b128 v[104:107], v18 offset:2048
    ds_read_b128 v[108:111], v19 offset:2048
    v_mfma_f32_16x16x32_bf16 v[216:219], v[56:59], v[80:83], v[216:219]
    ds_read_b128 v[112:115], v18 offset:4096
    ds_read_b128 v[116:119], v19 offset:4096
    v_mfma_f32_16x16x32_bf16 v[216:219], v[60:63], v[84:87], v[216:219]
    ds_read_b128 v[120:123], v18 offset:6144
    ds_read_b128 v[124:127], v19 offset:6144
    v_mfma_f32_16x16x32_bf16 v[248:251], v[60:63], v[92:95], v[248:251]
    v_mfma_f32_16x16x32_bf16 v[248:251], v[56:59], v[88:91], v[248:251]
    v_mfma_f32_16x16x32_bf16 v[252:255], v[40:43], v[88:91], v[252:255]
    ds_read_b64_tr_b16 v[56:57], v24 offset:8192
    ds_read_b64_tr_b16 v[58:59], v24 offset:8704
    v_mfma_f32_16x16x32_bf16 v[252:255], v[44:47], v[92:95], v[252:255]
    ds_read_b64_tr_b16 v[60:61], v24 offset:12288
    ds_read_b64_tr_b16 v[62:63], v24 offset:12800
    v_mfma_f32_16x16x32_bf16 v[220:223], v[44:47], v[84:87], v[220:223]
    v_mfma_f32_16x16x32_bf16 v[220:223], v[40:43], v[80:83], v[220:223]
    v_mfma_f32_16x16x32_bf16 v[188:191], v[40:43], v[72:75], v[188:191]
    v_mfma_f32_16x16x32_bf16 v[188:191], v[44:47], v[76:79], v[188:191]
    v_mfma_f32_16x16x32_bf16 v[156:159], v[44:47], v[68:71], v[156:159]
    v_mfma_f32_16x16x32_bf16 v[156:159], v[40:43], v[64:67], v[156:159]
    s_waitcnt lgkmcnt(13)
    v_mfma_f32_16x16x32_bf16 v[128:131], v[48:51], v[96:99], v[128:131]
    ds_read_b64_tr_b16 v[40:41], v25 offset:0
    s_waitcnt lgkmcnt(11)
    v_mfma_f32_16x16x32_bf16 v[128:131], v[52:55], v[100:103], v[128:131]
    ds_read_b64_tr_b16 v[42:43], v25 offset:512
    s_waitcnt lgkmcnt(10)
    v_mfma_f32_16x16x32_bf16 v[160:163], v[52:55], v[108:111], v[160:163]
    ds_read_b64_tr_b16 v[44:45], v25 offset:4096
    v_mfma_f32_16x16x32_bf16 v[160:163], v[48:51], v[104:107], v[160:163]
    ds_read_b64_tr_b16 v[46:47], v25 offset:4608
    s_waitcnt lgkmcnt(11)
    v_mfma_f32_16x16x32_bf16 v[192:195], v[48:51], v[112:115], v[192:195]
    s_waitcnt lgkmcnt(10)
    v_mfma_f32_16x16x32_bf16 v[192:195], v[52:55], v[116:119], v[192:195]
    s_waitcnt lgkmcnt(8)
    v_mfma_f32_16x16x32_bf16 v[224:227], v[52:55], v[124:127], v[224:227]
    v_mfma_f32_16x16x32_bf16 v[224:227], v[48:51], v[120:123], v[224:227]
    s_waitcnt lgkmcnt(6)
    v_mfma_f32_16x16x32_bf16 v[228:231], v[56:59], v[120:123], v[228:231]
    ds_read_b64_tr_b16 v[48:49], v25 offset:8192
    s_waitcnt lgkmcnt(5)
    v_mfma_f32_16x16x32_bf16 v[228:231], v[60:63], v[124:127], v[228:231]
    ds_read_b64_tr_b16 v[50:51], v25 offset:8704
    v_mfma_f32_16x16x32_bf16 v[196:199], v[60:63], v[116:119], v[196:199]
    ds_read_b64_tr_b16 v[52:53], v25 offset:12288
    v_mfma_f32_16x16x32_bf16 v[196:199], v[56:59], v[112:115], v[196:199]
    ds_read_b64_tr_b16 v[54:55], v25 offset:12800
    v_mfma_f32_16x16x32_bf16 v[164:167], v[56:59], v[104:107], v[164:167]
    v_mfma_f32_16x16x32_bf16 v[164:167], v[60:63], v[108:111], v[164:167]
    v_mfma_f32_16x16x32_bf16 v[132:135], v[60:63], v[100:103], v[132:135]
    v_mfma_f32_16x16x32_bf16 v[132:135], v[56:59], v[96:99], v[132:135]
    s_waitcnt lgkmcnt(6)
    v_mfma_f32_16x16x32_bf16 v[136:139], v[40:43], v[96:99], v[136:139]
    ds_read_b64_tr_b16 v[56:57], v26 offset:0
    s_waitcnt lgkmcnt(5)
    v_mfma_f32_16x16x32_bf16 v[136:139], v[44:47], v[100:103], v[136:139]
    ds_read_b64_tr_b16 v[58:59], v26 offset:512
    v_mfma_f32_16x16x32_bf16 v[168:171], v[44:47], v[108:111], v[168:171]
    ds_read_b64_tr_b16 v[60:61], v26 offset:4096
    v_mfma_f32_16x16x32_bf16 v[168:171], v[40:43], v[104:107], v[168:171]
    ds_read_b64_tr_b16 v[62:63], v26 offset:4608
    v_mfma_f32_16x16x32_bf16 v[200:203], v[40:43], v[112:115], v[200:203]
    v_mfma_f32_16x16x32_bf16 v[200:203], v[44:47], v[116:119], v[200:203]
    v_mfma_f32_16x16x32_bf16 v[232:235], v[44:47], v[124:127], v[232:235]
    v_mfma_f32_16x16x32_bf16 v[232:235], v[40:43], v[120:123], v[232:235]
    s_waitcnt lgkmcnt(6)
    v_mfma_f32_16x16x32_bf16 v[236:239], v[48:51], v[120:123], v[236:239]
    ds_read_b64_tr_b16 v[40:41], v26 offset:8192
    s_waitcnt lgkmcnt(5)
    v_mfma_f32_16x16x32_bf16 v[236:239], v[52:55], v[124:127], v[236:239]
    ds_read_b64_tr_b16 v[42:43], v26 offset:8704
    v_mfma_f32_16x16x32_bf16 v[204:207], v[52:55], v[116:119], v[204:207]
    ds_read_b64_tr_b16 v[44:45], v26 offset:12288
    v_mfma_f32_16x16x32_bf16 v[204:207], v[48:51], v[112:115], v[204:207]
    ds_read_b64_tr_b16 v[46:47], v26 offset:12800
    v_mfma_f32_16x16x32_bf16 v[172:175], v[48:51], v[104:107], v[172:175]
    v_mfma_f32_16x16x32_bf16 v[172:175], v[52:55], v[108:111], v[172:175]
    v_mfma_f32_16x16x32_bf16 v[140:143], v[52:55], v[100:103], v[140:143]
    v_mfma_f32_16x16x32_bf16 v[140:143], v[48:51], v[96:99], v[140:143]
    s_waitcnt lgkmcnt(6)
    v_mfma_f32_16x16x32_bf16 v[144:147], v[56:59], v[96:99], v[144:147]
    ds_read_b64_tr_b16 v[48:49], v27 offset:0
    s_waitcnt lgkmcnt(5)
    v_mfma_f32_16x16x32_bf16 v[144:147], v[60:63], v[100:103], v[144:147]
    ds_read_b64_tr_b16 v[50:51], v27 offset:512
    v_mfma_f32_16x16x32_bf16 v[176:179], v[60:63], v[108:111], v[176:179]
    ds_read_b64_tr_b16 v[52:53], v27 offset:4096
    v_mfma_f32_16x16x32_bf16 v[176:179], v[56:59], v[104:107], v[176:179]
    ds_read_b64_tr_b16 v[54:55], v27 offset:4608
    v_mfma_f32_16x16x32_bf16 v[208:211], v[56:59], v[112:115], v[208:211]
    v_mfma_f32_16x16x32_bf16 v[208:211], v[60:63], v[116:119], v[208:211]
    v_mfma_f32_16x16x32_bf16 v[240:243], v[60:63], v[124:127], v[240:243]
    v_mfma_f32_16x16x32_bf16 v[240:243], v[56:59], v[120:123], v[240:243]
    s_waitcnt lgkmcnt(6)
    v_mfma_f32_16x16x32_bf16 v[244:247], v[40:43], v[120:123], v[244:247]
    ds_read_b64_tr_b16 v[56:57], v27 offset:8192
    ds_read_b64_tr_b16 v[58:59], v27 offset:8704
    s_waitcnt lgkmcnt(6)
    v_mfma_f32_16x16x32_bf16 v[244:247], v[44:47], v[124:127], v[244:247]
    ds_read_b64_tr_b16 v[60:61], v27 offset:12288
    ds_read_b64_tr_b16 v[62:63], v27 offset:12800
    v_mfma_f32_16x16x32_bf16 v[212:215], v[44:47], v[116:119], v[212:215]
    v_mfma_f32_16x16x32_bf16 v[212:215], v[40:43], v[112:115], v[212:215]
    v_mfma_f32_16x16x32_bf16 v[180:183], v[40:43], v[104:107], v[180:183]
    v_mfma_f32_16x16x32_bf16 v[180:183], v[44:47], v[108:111], v[180:183]
    v_mfma_f32_16x16x32_bf16 v[148:151], v[44:47], v[100:103], v[148:151]
    v_mfma_f32_16x16x32_bf16 v[148:151], v[40:43], v[96:99], v[148:151]
    s_waitcnt lgkmcnt(6)
    v_mfma_f32_16x16x32_bf16 v[152:155], v[48:51], v[96:99], v[152:155]
    s_waitcnt lgkmcnt(0)
    s_barrier
    ds_read_b128 v[64:67], v16 offset:49152
    ds_read_b64_tr_b16 v[40:41], v20 offset:49152
    v_mfma_f32_16x16x32_bf16 v[152:155], v[52:55], v[100:103], v[152:155]
    ds_read_b64_tr_b16 v[42:43], v20 offset:49664
    ds_read_b128 v[68:71], v17 offset:49152
    v_mfma_f32_16x16x32_bf16 v[184:187], v[52:55], v[108:111], v[184:187]
    ds_read_b64_tr_b16 v[44:45], v20 offset:53248
    ds_read_b64_tr_b16 v[46:47], v20 offset:53760
    v_mfma_f32_16x16x32_bf16 v[184:187], v[48:51], v[104:107], v[184:187]
    ds_read_b128 v[72:75], v16 offset:51200
    ds_read_b128 v[76:79], v17 offset:51200
    v_mfma_f32_16x16x32_bf16 v[216:219], v[48:51], v[112:115], v[216:219]
    ds_read_b128 v[80:83], v16 offset:53248
    ds_read_b128 v[84:87], v17 offset:53248
    v_mfma_f32_16x16x32_bf16 v[216:219], v[52:55], v[116:119], v[216:219]
    ds_read_b128 v[88:91], v16 offset:55296
    ds_read_b128 v[92:95], v17 offset:55296
    v_mfma_f32_16x16x32_bf16 v[248:251], v[52:55], v[124:127], v[248:251]
    v_mfma_f32_16x16x32_bf16 v[248:251], v[48:51], v[120:123], v[248:251]
    v_mfma_f32_16x16x32_bf16 v[252:255], v[56:59], v[120:123], v[252:255]
    ds_read_b64_tr_b16 v[48:49], v20 offset:57344
    ds_read_b64_tr_b16 v[50:51], v20 offset:57856
    v_mfma_f32_16x16x32_bf16 v[252:255], v[60:63], v[124:127], v[252:255]
    ds_read_b64_tr_b16 v[52:53], v20 offset:61440
    ds_read_b64_tr_b16 v[54:55], v20 offset:61952
    v_mfma_f32_16x16x32_bf16 v[220:223], v[60:63], v[116:119], v[220:223]
    v_mfma_f32_16x16x32_bf16 v[220:223], v[56:59], v[112:115], v[220:223]
    v_mfma_f32_16x16x32_bf16 v[188:191], v[56:59], v[104:107], v[188:191]
    v_mfma_f32_16x16x32_bf16 v[188:191], v[60:63], v[108:111], v[188:191]
    v_mfma_f32_16x16x32_bf16 v[156:159], v[60:63], v[100:103], v[156:159]
    v_mfma_f32_16x16x32_bf16 v[156:159], v[56:59], v[96:99], v[156:159]
    s_waitcnt lgkmcnt(13)
    v_mfma_f32_16x16x32_bf16 v[128:131], v[40:43], v[64:67], v[128:131]
    ds_read_b64_tr_b16 v[56:57], v21 offset:49152
    s_waitcnt lgkmcnt(11)
    v_mfma_f32_16x16x32_bf16 v[128:131], v[44:47], v[68:71], v[128:131]
    ds_read_b64_tr_b16 v[58:59], v21 offset:49664
    s_waitcnt lgkmcnt(10)
    v_mfma_f32_16x16x32_bf16 v[160:163], v[44:47], v[76:79], v[160:163]
    ds_read_b64_tr_b16 v[60:61], v21 offset:53248
    v_mfma_f32_16x16x32_bf16 v[160:163], v[40:43], v[72:75], v[160:163]
    ds_read_b64_tr_b16 v[62:63], v21 offset:53760
    s_waitcnt lgkmcnt(11)
    v_mfma_f32_16x16x32_bf16 v[192:195], v[40:43], v[80:83], v[192:195]
    s_waitcnt lgkmcnt(10)
    v_mfma_f32_16x16x32_bf16 v[192:195], v[44:47], v[84:87], v[192:195]
    s_waitcnt lgkmcnt(8)
    v_mfma_f32_16x16x32_bf16 v[224:227], v[44:47], v[92:95], v[224:227]
    v_mfma_f32_16x16x32_bf16 v[224:227], v[40:43], v[88:91], v[224:227]
    s_waitcnt lgkmcnt(6)
    v_mfma_f32_16x16x32_bf16 v[228:231], v[48:51], v[88:91], v[228:231]
    ds_read_b64_tr_b16 v[40:41], v21 offset:57344
    s_waitcnt lgkmcnt(5)
    v_mfma_f32_16x16x32_bf16 v[228:231], v[52:55], v[92:95], v[228:231]
    ds_read_b64_tr_b16 v[42:43], v21 offset:57856
    v_mfma_f32_16x16x32_bf16 v[196:199], v[52:55], v[84:87], v[196:199]
    ds_read_b64_tr_b16 v[44:45], v21 offset:61440
    v_mfma_f32_16x16x32_bf16 v[196:199], v[48:51], v[80:83], v[196:199]
    ds_read_b64_tr_b16 v[46:47], v21 offset:61952
    v_mfma_f32_16x16x32_bf16 v[164:167], v[48:51], v[72:75], v[164:167]
    v_mfma_f32_16x16x32_bf16 v[164:167], v[52:55], v[76:79], v[164:167]
    v_mfma_f32_16x16x32_bf16 v[132:135], v[52:55], v[68:71], v[132:135]
    v_mfma_f32_16x16x32_bf16 v[132:135], v[48:51], v[64:67], v[132:135]
    s_waitcnt lgkmcnt(6)
    v_mfma_f32_16x16x32_bf16 v[136:139], v[56:59], v[64:67], v[136:139]
    ds_read_b64_tr_b16 v[48:49], v22 offset:49152
    s_waitcnt lgkmcnt(5)
    v_mfma_f32_16x16x32_bf16 v[136:139], v[60:63], v[68:71], v[136:139]
    ds_read_b64_tr_b16 v[50:51], v22 offset:49664
    v_mfma_f32_16x16x32_bf16 v[168:171], v[60:63], v[76:79], v[168:171]
    ds_read_b64_tr_b16 v[52:53], v22 offset:53248
    v_mfma_f32_16x16x32_bf16 v[168:171], v[56:59], v[72:75], v[168:171]
    ds_read_b64_tr_b16 v[54:55], v22 offset:53760
    v_mfma_f32_16x16x32_bf16 v[200:203], v[56:59], v[80:83], v[200:203]
    v_mfma_f32_16x16x32_bf16 v[200:203], v[60:63], v[84:87], v[200:203]
    v_mfma_f32_16x16x32_bf16 v[232:235], v[60:63], v[92:95], v[232:235]
    v_mfma_f32_16x16x32_bf16 v[232:235], v[56:59], v[88:91], v[232:235]
    s_waitcnt lgkmcnt(6)
    v_mfma_f32_16x16x32_bf16 v[236:239], v[40:43], v[88:91], v[236:239]
    ds_read_b64_tr_b16 v[56:57], v22 offset:57344
    s_waitcnt lgkmcnt(5)
    v_mfma_f32_16x16x32_bf16 v[236:239], v[44:47], v[92:95], v[236:239]
    ds_read_b64_tr_b16 v[58:59], v22 offset:57856
    v_mfma_f32_16x16x32_bf16 v[204:207], v[44:47], v[84:87], v[204:207]
    ds_read_b64_tr_b16 v[60:61], v22 offset:61440
    v_mfma_f32_16x16x32_bf16 v[204:207], v[40:43], v[80:83], v[204:207]
    ds_read_b64_tr_b16 v[62:63], v22 offset:61952
    v_mfma_f32_16x16x32_bf16 v[172:175], v[40:43], v[72:75], v[172:175]
    v_mfma_f32_16x16x32_bf16 v[172:175], v[44:47], v[76:79], v[172:175]
    v_mfma_f32_16x16x32_bf16 v[140:143], v[44:47], v[68:71], v[140:143]
    v_mfma_f32_16x16x32_bf16 v[140:143], v[40:43], v[64:67], v[140:143]
    s_waitcnt lgkmcnt(6)
    v_mfma_f32_16x16x32_bf16 v[144:147], v[48:51], v[64:67], v[144:147]
    ds_read_b64_tr_b16 v[40:41], v23 offset:49152
    s_waitcnt lgkmcnt(5)
    v_mfma_f32_16x16x32_bf16 v[144:147], v[52:55], v[68:71], v[144:147]
    ds_read_b64_tr_b16 v[42:43], v23 offset:49664
    v_mfma_f32_16x16x32_bf16 v[176:179], v[52:55], v[76:79], v[176:179]
    ds_read_b64_tr_b16 v[44:45], v23 offset:53248
    v_mfma_f32_16x16x32_bf16 v[176:179], v[48:51], v[72:75], v[176:179]
    ds_read_b64_tr_b16 v[46:47], v23 offset:53760
    v_mfma_f32_16x16x32_bf16 v[208:211], v[48:51], v[80:83], v[208:211]
    v_mfma_f32_16x16x32_bf16 v[208:211], v[52:55], v[84:87], v[208:211]
    v_mfma_f32_16x16x32_bf16 v[240:243], v[52:55], v[92:95], v[240:243]
    v_mfma_f32_16x16x32_bf16 v[240:243], v[48:51], v[88:91], v[240:243]
    s_waitcnt lgkmcnt(6)
    v_mfma_f32_16x16x32_bf16 v[244:247], v[56:59], v[88:91], v[244:247]
    ds_read_b64_tr_b16 v[48:49], v23 offset:57344
    ds_read_b64_tr_b16 v[50:51], v23 offset:57856
    s_waitcnt lgkmcnt(6)
    v_mfma_f32_16x16x32_bf16 v[244:247], v[60:63], v[92:95], v[244:247]
    ds_read_b64_tr_b16 v[52:53], v23 offset:61440
    ds_read_b64_tr_b16 v[54:55], v23 offset:61952
    v_mfma_f32_16x16x32_bf16 v[212:215], v[60:63], v[84:87], v[212:215]
    v_mfma_f32_16x16x32_bf16 v[212:215], v[56:59], v[80:83], v[212:215]
    ds_read_b32 v35, v11 offset:1164
    v_mfma_f32_16x16x32_bf16 v[180:183], v[56:59], v[72:75], v[180:183]
    v_mfma_f32_16x16x32_bf16 v[180:183], v[60:63], v[76:79], v[180:183]
    v_mfma_f32_16x16x32_bf16 v[148:151], v[60:63], v[68:71], v[148:151]
    v_mfma_f32_16x16x32_bf16 v[148:151], v[56:59], v[64:67], v[148:151]
    s_waitcnt lgkmcnt(7)
    v_mfma_f32_16x16x32_bf16 v[152:155], v[40:43], v[64:67], v[152:155]
    s_waitcnt lgkmcnt(0)
    v_readfirstlane_b32 s60, v35
    v_mfma_f32_16x16x32_bf16 v[152:155], v[44:47], v[68:71], v[152:155]
    s_mov_b64 exec, 1
    ds_add_u32 v11, v15 offset:1168
    s_mov_b64 exec, -1
    s_cmp_ge_u32 s60, 4
    s_cbranch_scc0 L_SLOW6
L_BACK6:
    ds_read_b128 v[96:99], v16 offset:0
    ds_read_b64_tr_b16 v[56:57], v20 offset:0
    v_mfma_f32_16x16x32_bf16 v[184:187], v[44:47], v[76:79], v[184:187]
    ds_read_b64_tr_b16 v[58:59], v20 offset:512
    ds_read_b128 v[100:103], v17 offset:0
    v_mfma_f32_16x16x32_bf16 v[184:187], v[40:43], v[72:75], v[184:187]
    ds_read_b64_tr_b16 v[60:61], v20 offset:4096
    ds_read_b64_tr_b16 v[62:63], v20 offset:4608
    v_mfma_f32_16x16x32_bf16 v[216:219], v[40:43], v[80:83], v[216:219]
    ds_read_b128 v[104:107], v16 offset:2048
    ds_read_b128 v[108:111], v17 offset:2048
    v_mfma_f32_16x16x32_bf16 v[216:219], v[44:47], v[84:87], v[216:219]
    ds_read_b128 v[112:115], v16 offset:4096
    ds_read_b128 v[116:119], v17 offset:4096
    v_mfma_f32_16x16x32_bf16 v[248:251], v[44:47], v[92:95], v[248:251]
    ds_read_b128 v[120:123], v16 offset:6144
    ds_read_b128 v[124:127], v17 offset:6144
    v_mfma_f32_16x16x32_bf16 v[248:251], v[40:43], v[88:91], v[248:251]
    v_mfma_f32_16x16x32_bf16 v[252:255], v[48:51], v[88:91], v[252:255]
    ds_read_b64_tr_b16 v[40:41], v20 offset:8192
    ds_read_b64_tr_b16 v[42:43], v20 offset:8704
    v_mfma_f32_16x16x32_bf16 v[252:255], v[52:55], v[92:95], v[252:255]
    ds_read_b64_tr_b16 v[44:45], v20 offset:12288
    ds_read_b64_tr_b16 v[46:47], v20 offset:12800
    v_mfma_f32_16x16x32_bf16 v[220:223], v[52:55], v[84:87], v[220:223]
    v_mfma_f32_16x16x32_bf16 v[220:223], v[48:51], v[80:83], v[220:223]
    v_mfma_f32_16x16x32_bf16 v[188:191], v[48:51], v[72:75], v[188:191]
    v_mfma_f32_16x16x32_bf16 v[188:191], v[52:55], v[76:79], v[188:191]
    v_mfma_f32_16x16x32_bf16 v[156:159], v[52:55], v[68:71], v[156:159]
    v_mfma_f32_16x16x32_bf16 v[156:159], v[48:51], v[64:67], v[156:159]
    s_waitcnt lgkmcnt(13)
    v_mfma_f32_16x16x32_bf16 v[128:131], v[56:59], v[96:99], v[128:131]
    ds_read_b64_tr_b16 v[48:49], v21 offset:0
    s_waitcnt lgkmcnt(11)
    v_mfma_f32_16x16x32_bf16 v[128:131], v[60:63], v[100:103], v[128:131]
    ds_read_b64_tr_b16 v[50:51], v21 offset:512
    s_waitcnt lgkmcnt(10)
    v_mfma_f32_16x16x32_bf16 v[160:163], v[60:63], v[108:111], v[160:163]
    ds_read_b64_tr_b16 v[52:53], v21 offset:4096
    v_mov_b32 v66, 0
    v_mfma_f32_16x16x32_bf16 v[160:163], v[56:59], v[104:107], v[160:163]
    ds_read_b64_tr_b16 v[54:55], v21 offset:4608
    v_mov_b32 v67, 0
    s_waitcnt lgkmcnt(11)
    v_mfma_f32_16x16x32_bf16 v[192:195], v[56:59], v[112:115], v[192:195]
    v_mov_b32 v70, 0
    v_mov_b32 v71, 0
    s_waitcnt lgkmcnt(10)
    v_mfma_f32_16x16x32_bf16 v[192:195], v[60:63], v[116:119], v[192:195]
    v_mov_b32 v74, 0
    v_mov_b32 v75, 0
    s_waitcnt lgkmcnt(8)
    v_mfma_f32_16x16x32_bf16 v[224:227], v[60:63], v[124:127], v[224:227]
    v_mov_b32 v78, 0
    v_mov_b32 v79, 0
    v_mfma_f32_16x16x32_bf16 v[224:227], v[56:59], v[120:123], v[224:227]
    s_waitcnt lgkmcnt(6)
    v_mfma_f32_16x16x32_bf16 v[228:231], v[40:43], v[120:123], v[228:231]
    ds_read_b64_tr_b16 v[56:57], v21 offset:8192
    s_waitcnt lgkmcnt(5)
    v_mfma_f32_16x16x32_bf16 v[228:231], v[44:47], v[124:127], v[228:231]
    ds_read_b64_tr_b16 v[58:59], v21 offset:8704
    v_mfma_f32_16x16x32_bf16 v[196:199], v[44:47], v[116:119], v[196:199]
    ds_read_b64_tr_b16 v[60:61], v21 offset:12288
    v_mfma_f32_16x16x32_bf16 v[196:199], v[40:43], v[112:115], v[196:199]
    ds_read_b64_tr_b16 v[62:63], v21 offset:12800
    v_mfma_f32_16x16x32_bf16 v[164:167], v[40:43], v[104:107], v[164:167]
    v_mfma_f32_16x16x32_bf16 v[164:167], v[44:47], v[108:111], v[164:167]
    v_mfma_f32_16x16x32_bf16 v[132:135], v[44:47], v[100:103], v[132:135]
    v_mfma_f32_16x16x32_bf16 v[132:135], v[40:43], v[96:99], v[132:135]
    s_waitcnt lgkmcnt(6)
    v_mfma_f32_16x16x32_bf16 v[136:139], v[48:51], v[96:99], v[136:139]
    ds_read_b64_tr_b16 v[40:41], v22 offset:0
    s_waitcnt lgkmcnt(5)
    v_mfma_f32_16x16x32_bf16 v[136:139], v[52:55], v[100:103], v[136:139]
    ds_read_b64_tr_b16 v[42:43], v22 offset:512
    v_mfma_f32_16x16x32_bf16 v[168:171], v[52:55], v[108:111], v[168:171]
    ds_read_b64_tr_b16 v[44:45], v22 offset:4096
    v_mfma_f32_16x16x32_bf16 v[168:171], v[48:51], v[104:107], v[168:171]
    ds_read_b64_tr_b16 v[46:47], v22 offset:4608
    v_mfma_f32_16x16x32_bf16 v[200:203], v[48:51], v[112:115], v[200:203]
    v_mfma_f32_16x16x32_bf16 v[200:203], v[52:55], v[116:119], v[200:203]
    v_mfma_f32_16x16x32_bf16 v[232:235], v[52:55], v[124:127], v[232:235]
    v_mfma_f32_16x16x32_bf16 v[232:235], v[48:51], v[120:123], v[232:235]
    s_waitcnt lgkmcnt(6)
    v_mfma_f32_16x16x32_bf16 v[236:239], v[56:59], v[120:123], v[236:239]
    ds_read_b32 v35, v11 offset:1180
    s_waitcnt lgkmcnt(5)
    v_mfma_f32_16x16x32_bf16 v[236:239], v[60:63], v[124:127], v[236:239]
    ds_read_b64_tr_b16 v[48:49], v22 offset:8192
    v_mfma_f32_16x16x32_bf16 v[204:207], v[60:63], v[116:119], v[204:207]
    ds_read_b64_tr_b16 v[50:51], v22 offset:8704
    v_mfma_f32_16x16x32_bf16 v[204:207], v[56:59], v[112:115], v[204:207]
    ds_read_b64_tr_b16 v[52:53], v22 offset:12288
    v_mfma_f32_16x16x32_bf16 v[172:175], v[56:59], v[104:107], v[172:175]
    ds_read_b64_tr_b16 v[54:55], v22 offset:12800
    v_mfma_f32_16x16x32_bf16 v[172:175], v[60:63], v[108:111], v[172:175]
    v_mfma_f32_16x16x32_bf16 v[140:143], v[60:63], v[100:103], v[140:143]
    s_waitcnt lgkmcnt(4)
    v_readfirstlane_b32 s60, v35
    v_mfma_f32_16x16x32_bf16 v[140:143], v[56:59], v[96:99], v[140:143]
    s_cmp_ge_u32 s60, 4
    s_cbranch_scc0 L_SLOW7
L_BACK7:
    ds_read_b32 v28, v10 offset:0
    v_mfma_f32_16x16x32_bf16 v[144:147], v[40:43], v[96:99], v[144:147]
    ds_read_b64_tr_b16 v[56:57], v23 offset:0
    v_mfma_f32_16x16x32_bf16 v[144:147], v[44:47], v[100:103], v[144:147]
    ds_read_b64_tr_b16 v[58:59], v23 offset:512
    v_mfma_f32_16x16x32_bf16 v[176:179], v[44:47], v[108:111], v[176:179]
    ds_read_b64_tr_b16 v[60:61], v23 offset:4096
    v_mfma_f32_16x16x32_bf16 v[176:179], v[40:43], v[104:107], v[176:179]
    ds_read_b64_tr_b16 v[62:63], v23 offset:4608
    v_mfma_f32_16x16x32_bf16 v[208:211], v[40:43], v[112:115], v[208:211]
    ds_read_b32 v29, v10 offset:64
    v_mfma_f32_16x16x32_bf16 v[208:211], v[44:47], v[116:119], v[208:211]
    ds_read_b32 v30, v10 offset:128
    v_mfma_f32_16x16x32_bf16 v[240:243], v[44:47], v[124:127], v[240:243]
    ds_read_b32 v31, v10 offset:192
    v_mfma_f32_16x16x32_bf16 v[240:243], v[40:43], v[120:123], v[240:243]
    ds_read_b32 v34, v11 offset:1024
    s_waitcnt lgkmcnt(11)
    v_mfma_f32_16x16x32_bf16 v[244:247], v[48:51], v[120:123], v[244:247]
    ds_read_b64_tr_b16 v[40:41], v23 offset:8192
    ds_read_b64_tr_b16 v[42:43], v23 offset:8704
    s_waitcnt lgkmcnt(11)
    v_mfma_f32_16x16x32_bf16 v[244:247], v[52:55], v[124:127], v[244:247]
    ds_read_b64_tr_b16 v[44:45], v23 offset:12288
    ds_read_b64_tr_b16 v[46:47], v23 offset:12800
    v_mfma_f32_16x16x32_bf16 v[212:215], v[52:55], v[116:119], v[212:215]
    s_waitcnt lgkmcnt(12)
    v_perm_b32 v1, v28, v28, s65
    v_and_b32 v28, 0xffff0000, v28
    v_mfma_f32_16x16x32_bf16 v[212:215], v[48:51], v[112:115], v[212:215]
    v_xor_b32 v64, 0x80008000, v1
    v_rcp_f32 v2, v28
    v_mfma_f32_16x16x32_bf16 v[180:183], v[48:51], v[104:107], v[180:183]
    v_xor_b32 v65, 0x80008000, v1
    v_mul_f32 v88, v28, v28
    v_mfma_f32_16x16x32_bf16 v[180:183], v[52:55], v[108:111], v[180:183]
    v_mul_f32 v81, 0xc0135761, v2
    v_mul_f32 v2, v2, v2
    v_mfma_f32_16x16x32_bf16 v[148:151], v[52:55], v[100:103], v[148:151]
    v_mul_f32 v2, 0x3d372713, v2
    v_mul_f32 v80, v2, v81
    v_mfma_f32_16x16x32_bf16 v[148:151], v[48:51], v[96:99], v[148:151]
    s_waitcnt lgkmcnt(7)
    v_perm_b32 v1, v29, v29, s65
    v_and_b32 v29, 0xffff0000, v29
    v_mfma_f32_16x16x32_bf16 v[152:155], v[56:59], v[96:99], v[152:155]
    s_waitcnt lgkmcnt(0)
    ds_read_b64 v[48:49], v9 offset:1536
    ds_read_b64 v[52:53], v9 offset:1664
    v_mfma_f32_16x16x32_bf16 v[152:155], v[60:63], v[100:103], v[152:155]
    s_mov_b64 exec, 1
    ds_add_u32 v11, v15 offset:1172
    s_mov_b64 exec, -1
    v_xor_b32 v68, 0x80008000, v1
    v_rcp_f32 v2, v29
    v_mfma_f32_16x16x32_bf16 v[184:187], v[60:63], v[108:111], v[184:187]
    v_xor_b32 v69, 0x80008000, v1
    v_mul_f32 v89, v29, v29
    v_mfma_f32_16x16x32_bf16 v[184:187], v[56:59], v[104:107], v[184:187]
    v_mul_f32 v83, 0xc0135761, v2
    v_mul_f32 v2, v2, v2
    v_mfma_f32_16x16x32_bf16 v[216:219], v[56:59], v[112:115], v[216:219]
    v_mul_f32 v2, 0x3d372713, v2
    v_mul_f32 v82, v2, v83
    v_mfma_f32_16x16x32_bf16 v[216:219], v[60:63], v[116:119], v[216:219]
    v_perm_b32 v1, v30, v30, s65
    v_and_b32 v30, 0xffff0000, v30
    v_mfma_f32_16x16x32_bf16 v[248:251], v[60:63], v[124:127], v[248:251]
    v_xor_b32 v72, 0x80008000, v1
    v_rcp_f32 v2, v30
    v_mfma_f32_16x16x32_bf16 v[248:251], v[56:59], v[120:123], v[248:251]
    v_xor_b32 v73, 0x80008000, v1
    v_mul_f32 v90, v30, v30
    v_mfma_f32_16x16x32_bf16 v[252:255], v[40:43], v[120:123], v[252:255]
    ds_read_b64 v[56:57], v9 offset:1792
    ds_read_b64 v[60:61], v9 offset:1920
    v_mfma_f32_16x16x32_bf16 v[252:255], v[44:47], v[124:127], v[252:255]
    v_mul_f32 v85, 0xc0135761, v2
    v_mul_f32 v2, v2, v2
    v_mfma_f32_16x16x32_bf16 v[220:223], v[44:47], v[116:119], v[220:223]
    v_mul_f32 v2, 0x3d372713, v2
    v_mul_f32 v84, v2, v85
    v_mfma_f32_16x16x32_bf16 v[220:223], v[40:43], v[112:115], v[220:223]
    v_perm_b32 v1, v31, v31, s65
    v_and_b32 v31, 0xffff0000, v31
    v_mfma_f32_16x16x32_bf16 v[188:191], v[40:43], v[104:107], v[188:191]
    v_xor_b32 v76, 0x80008000, v1
    v_rcp_f32 v2, v31
    v_mfma_f32_16x16x32_bf16 v[188:191], v[44:47], v[108:111], v[188:191]
    v_xor_b32 v77, 0x80008000, v1
    v_mul_f32 v91, v31, v31
    v_mfma_f32_16x16x32_bf16 v[156:159], v[44:47], v[100:103], v[156:159]
    v_mul_f32 v87, 0xc0135761, v2
    v_mul_f32 v2, v2, v2
    v_mfma_f32_16x16x32_bf16 v[156:159], v[40:43], v[96:99], v[156:159]
    v_mul_f32 v2, 0x3d372713, v2
    v_mul_f32 v86, v2, v87
    s_waitcnt lgkmcnt(4)
    v_mfma_f32_16x16x32_bf16 v[128:131], v[48:51], v[64:67], v[128:131]
    ds_read_b64 v[112:113], v9 offset:2048
    s_waitcnt lgkmcnt(4)
    v_mfma_f32_16x16x32_bf16 v[132:135], v[52:55], v[64:67], v[132:135]
    ds_read_b64 v[116:117], v9 offset:2176
    s_waitcnt lgkmcnt(3)
    v_mfma_f32_16x16x32_bf16 v[136:139], v[56:59], v[64:67], v[136:139]
    ds_read_b64 v[120:121], v9 offset:2304
    s_waitcnt lgkmcnt(3)
    v_mfma_f32_16x16x32_bf16 v[140:143], v[60:63], v[64:67], v[140:143]
    ds_read_b64 v[124:125], v9 offset:2432
    v_mfma_f32_16x16x32_bf16 v[160:163], v[48:51], v[68:71], v[160:163]
    v_mfma_f32_16x16x32_bf16 v[164:167], v[52:55], v[68:71], v[164:167]
    v_mfma_f32_16x16x32_bf16 v[168:171], v[56:59], v[68:71], v[168:171]
    v_mfma_f32_16x16x32_bf16 v[172:175], v[60:63], v[68:71], v[172:175]
    v_readfirstlane_b32 s70, v34
    s_waitcnt lgkmcnt(0)
    s_xor_b32 s71, s70, 1540483477
    v_pk_mul_f32 v[96:97], v[128:129], v[128:129]
    v_pk_mul_f32 v[98:99], v[130:131], v[130:131]
    v_pk_mul_f32 v[100:101], v[136:137], v[136:137]
    v_pk_mul_f32 v[102:103], v[138:139], v[138:139]
    v_pk_fma_f32 v[96:97], v[96:97], v[80:81], v[80:81] op_sel:[0,0,1] op_sel_hi:[1,0,1]
    v_pk_fma_f32 v[98:99], v[98:99], v[80:81], v[80:81] op_sel:[0,0,1] op_sel_hi:[1,0,1]
    v_pk_fma_f32 v[100:101], v[100:101], v[80:81], v[80:81] op_sel:[0,0,1] op_sel_hi:[1,0,1]
    v_pk_fma_f32 v[102:103], v[102:103], v[80:81], v[80:81] op_sel:[0,0,1] op_sel_hi:[1,0,1]
    v_pk_mul_f32 v[96:97], v[96:97], v[128:129]
    v_pk_mul_f32 v[98:99], v[98:99], v[130:131]
    v_pk_mul_f32 v[100:101], v[100:101], v[136:137]
    v_pk_mul_f32 v[102:103], v[102:103], v[138:139]
    v_mfma_f32_16x16x32_bf16 v[192:195], v[48:51], v[72:75], v[192:195]
    v_exp_f32 v96, v96
    v_exp_f32 v97, v97
    v_mfma_f32_16x16x32_bf16 v[196:199], v[52:55], v[72:75], v[196:199]
    v_exp_f32 v98, v98
    v_exp_f32 v99, v99
    v_exp_f32 v100, v100
    v_exp_f32 v101, v101
    v_exp_f32 v102, v102
    v_exp_f32 v103, v103
    v_pk_mul_f32 v[128:129], v[128:129], v[132:133]
    v_pk_mul_f32 v[130:131], v[130:131], v[134:135]
    v_pk_mul_f32 v[136:137], v[136:137], v[140:141]
    v_pk_mul_f32 v[138:139], v[138:139], v[142:143]
    v_pk_fma_f32 v[96:97], v[96:97], v[88:89], v[88:89] op_sel:[0,0,0] op_sel_hi:[1,0,0]
    v_pk_fma_f32 v[98:99], v[98:99], v[88:89], v[88:89] op_sel:[0,0,0] op_sel_hi:[1,0,0]
    v_pk_fma_f32 v[100:101], v[100:101], v[88:89], v[88:89] op_sel:[0,0,0] op_sel_hi:[1,0,0]
    v_pk_fma_f32 v[102:103], v[102:103], v[88:89], v[88:89] op_sel:[0,0,0] op_sel_hi:[1,0,0]
    v_mfma_f32_16x16x32_bf16 v[200:203], v[56:59], v[72:75], v[200:203]
    v_rcp_f32 v96, v96
    v_rcp_f32 v97, v97
    v_mfma_f32_16x16x32_bf16 v[204:207], v[60:63], v[72:75], v[204:207]
    v_rcp_f32 v98, v98
    v_rcp_f32 v99, v99
    v_rcp_f32 v100, v100
    v_rcp_f32 v101, v101
    v_rcp_f32 v102, v102
    v_rcp_f32 v103, v103
    v_pk_mul_f32 v[128:129], v[128:129], v[96:97]
    v_pk_mul_f32 v[130:131], v[130:131], v[98:99]
    v_pk_mul_f32 v[136:137], v[136:137], v[100:101]
    v_pk_mul_f32 v[138:139], v[138:139], v[102:103]
    v_cvt_pk_bf16_f32 v132, v128, v129
    v_cvt_pk_bf16_f32 v133, v130, v131
    v_cvt_pk_bf16_f32 v134, v136, v137
    v_cvt_pk_bf16_f32 v135, v138, v139
    buffer_store_dwordx4 v[132:135], v8, s[40:43], s64 offen offset:0 sc1
    v_pk_mul_f32 v[104:105], v[160:161], v[160:161]
    v_pk_mul_f32 v[106:107], v[162:163], v[162:163]
    v_pk_mul_f32 v[108:109], v[168:169], v[168:169]
    v_pk_mul_f32 v[110:111], v[170:171], v[170:171]
    v_pk_fma_f32 v[104:105], v[104:105], v[82:83], v[82:83] op_sel:[0,0,1] op_sel_hi:[1,0,1]
    v_pk_fma_f32 v[106:107], v[106:107], v[82:83], v[82:83] op_sel:[0,0,1] op_sel_hi:[1,0,1]
    v_pk_fma_f32 v[108:109], v[108:109], v[82:83], v[82:83] op_sel:[0,0,1] op_sel_hi:[1,0,1]
    v_pk_fma_f32 v[110:111], v[110:111], v[82:83], v[82:83] op_sel:[0,0,1] op_sel_hi:[1,0,1]
    v_pk_mul_f32 v[104:105], v[104:105], v[160:161]
    v_pk_mul_f32 v[106:107], v[106:107], v[162:163]
    v_pk_mul_f32 v[108:109], v[108:109], v[168:169]
    v_pk_mul_f32 v[110:111], v[110:111], v[170:171]
    v_mfma_f32_16x16x32_bf16 v[224:227], v[48:51], v[76:79], v[224:227]
    v_exp_f32 v104, v104
    v_exp_f32 v105, v105
    v_mfma_f32_16x16x32_bf16 v[228:231], v[52:55], v[76:79], v[228:231]
    v_exp_f32 v106, v106
    v_exp_f32 v107, v107
    v_exp_f32 v108, v108
    v_exp_f32 v109, v109
    v_exp_f32 v110, v110
    v_exp_f32 v111, v111
    v_pk_mul_f32 v[160:161], v[160:161], v[164:165]
    v_pk_mul_f32 v[162:163], v[162:163], v[166:167]
    v_pk_mul_f32 v[168:169], v[168:169], v[172:173]
    v_pk_mul_f32 v[170:171], v[170:171], v[174:175]
    v_pk_fma_f32 v[104:105], v[104:105], v[88:89], v[88:89] op_sel:[0,1,1] op_sel_hi:[1,1,1]
    v_pk_fma_f32 v[106:107], v[106:107], v[88:89], v[88:89] op_sel:[0,1,1] op_sel_hi:[1,1,1]
    v_pk_fma_f32 v[108:109], v[108:109], v[88:89], v[88:89] op_sel:[0,1,1] op_sel_hi:[1,1,1]
    v_pk_fma_f32 v[110:111], v[110:111], v[88:89], v[88:89] op_sel:[0,1,1] op_sel_hi:[1,1,1]
    v_mfma_f32_16x16x32_bf16 v[232:235], v[56:59], v[76:79], v[232:235]
    v_rcp_f32 v104, v104
    v_rcp_f32 v105, v105
    v_mfma_f32_16x16x32_bf16 v[236:239], v[60:63], v[76:79], v[236:239]
    v_rcp_f32 v106, v106
    v_rcp_f32 v107, v107
    v_rcp_f32 v108, v108
    v_rcp_f32 v109, v109
    v_rcp_f32 v110, v110
    v_rcp_f32 v111, v111
    v_pk_mul_f32 v[160:161], v[160:161], v[104:105]
    v_pk_mul_f32 v[162:163], v[162:163], v[106:107]
    v_pk_mul_f32 v[168:169], v[168:169], v[108:109]
    v_pk_mul_f32 v[170:171], v[170:171], v[110:111]
    v_cvt_pk_bf16_f32 v164, v160, v161
    v_cvt_pk_bf16_f32 v165, v162, v163
    v_cvt_pk_bf16_f32 v166, v168, v169
    v_cvt_pk_bf16_f32 v167, v170, v171
    buffer_store_dwordx4 v[164:167], v8, s[40:43], s64 offen offset:1024 sc1
    v_pk_mul_f32 v[96:97], v[192:193], v[192:193]
    v_pk_mul_f32 v[98:99], v[194:195], v[194:195]
    v_pk_mul_f32 v[100:101], v[200:201], v[200:201]
    v_pk_mul_f32 v[102:103], v[202:203], v[202:203]
    v_pk_fma_f32 v[96:97], v[96:97], v[84:85], v[84:85] op_sel:[0,0,1] op_sel_hi:[1,0,1]
    v_pk_fma_f32 v[98:99], v[98:99], v[84:85], v[84:85] op_sel:[0,0,1] op_sel_hi:[1,0,1]
    v_pk_fma_f32 v[100:101], v[100:101], v[84:85], v[84:85] op_sel:[0,0,1] op_sel_hi:[1,0,1]
    v_pk_fma_f32 v[102:103], v[102:103], v[84:85], v[84:85] op_sel:[0,0,1] op_sel_hi:[1,0,1]
    v_pk_mul_f32 v[96:97], v[96:97], v[192:193]
    v_pk_mul_f32 v[98:99], v[98:99], v[194:195]
    v_pk_mul_f32 v[100:101], v[100:101], v[200:201]
    v_pk_mul_f32 v[102:103], v[102:103], v[202:203]
    v_mfma_f32_16x16x32_bf16 v[144:147], v[112:115], v[64:67], v[144:147]
    v_exp_f32 v96, v96
    v_exp_f32 v97, v97
    v_mfma_f32_16x16x32_bf16 v[148:151], v[116:119], v[64:67], v[148:151]
    v_exp_f32 v98, v98
    v_exp_f32 v99, v99
    v_exp_f32 v100, v100
    v_exp_f32 v101, v101
    v_exp_f32 v102, v102
    v_exp_f32 v103, v103
    v_pk_mul_f32 v[192:193], v[192:193], v[196:197]
    v_pk_mul_f32 v[194:195], v[194:195], v[198:199]
    v_pk_mul_f32 v[200:201], v[200:201], v[204:205]
    v_pk_mul_f32 v[202:203], v[202:203], v[206:207]
    v_pk_fma_f32 v[96:97], v[96:97], v[90:91], v[90:91] op_sel:[0,0,0] op_sel_hi:[1,0,0]
    v_pk_fma_f32 v[98:99], v[98:99], v[90:91], v[90:91] op_sel:[0,0,0] op_sel_hi:[1,0,0]
    v_pk_fma_f32 v[100:101], v[100:101], v[90:91], v[90:91] op_sel:[0,0,0] op_sel_hi:[1,0,0]
    v_pk_fma_f32 v[102:103], v[102:103], v[90:91], v[90:91] op_sel:[0,0,0] op_sel_hi:[1,0,0]
    v_mfma_f32_16x16x32_bf16 v[152:155], v[120:123], v[64:67], v[152:155]
    v_rcp_f32 v96, v96
    v_rcp_f32 v97, v97
    v_mfma_f32_16x16x32_bf16 v[156:159], v[124:127], v[64:67], v[156:159]
    v_rcp_f32 v98, v98
    v_rcp_f32 v99, v99
    v_rcp_f32 v100, v100
    v_rcp_f32 v101, v101
    v_rcp_f32 v102, v102
    v_rcp_f32 v103, v103
    v_pk_mul_f32 v[192:193], v[192:193], v[96:97]
    v_pk_mul_f32 v[194:195], v[194:195], v[98:99]
    v_pk_mul_f32 v[200:201], v[200:201], v[100:101]
    v_pk_mul_f32 v[202:203], v[202:203], v[102:103]
    v_cvt_pk_bf16_f32 v196, v192, v193
    v_cvt_pk_bf16_f32 v197, v194, v195
    v_cvt_pk_bf16_f32 v198, v200, v201
    v_cvt_pk_bf16_f32 v199, v202, v203
    buffer_store_dwordx4 v[196:199], v8, s[40:43], s64 offen offset:2048 sc1
    v_pk_mul_f32 v[104:105], v[224:225], v[224:225]
    v_pk_mul_f32 v[106:107], v[226:227], v[226:227]
    v_pk_mul_f32 v[108:109], v[232:233], v[232:233]
    v_pk_mul_f32 v[110:111], v[234:235], v[234:235]
    v_pk_fma_f32 v[104:105], v[104:105], v[86:87], v[86:87] op_sel:[0,0,1] op_sel_hi:[1,0,1]
    v_pk_fma_f32 v[106:107], v[106:107], v[86:87], v[86:87] op_sel:[0,0,1] op_sel_hi:[1,0,1]
    v_pk_fma_f32 v[108:109], v[108:109], v[86:87], v[86:87] op_sel:[0,0,1] op_sel_hi:[1,0,1]
    v_pk_fma_f32 v[110:111], v[110:111], v[86:87], v[86:87] op_sel:[0,0,1] op_sel_hi:[1,0,1]
    v_pk_mul_f32 v[104:105], v[104:105], v[224:225]
    v_pk_mul_f32 v[106:107], v[106:107], v[226:227]
    v_pk_mul_f32 v[108:109], v[108:109], v[232:233]
    v_pk_mul_f32 v[110:111], v[110:111], v[234:235]
    v_mfma_f32_16x16x32_bf16 v[176:179], v[112:115], v[68:71], v[176:179]
    v_exp_f32 v104, v104
    v_exp_f32 v105, v105
    v_mfma_f32_16x16x32_bf16 v[180:183], v[116:119], v[68:71], v[180:183]
    v_exp_f32 v106, v106
    v_exp_f32 v107, v107
    v_exp_f32 v108, v108
    v_exp_f32 v109, v109
    v_exp_f32 v110, v110
    v_exp_f32 v111, v111
    v_pk_mul_f32 v[224:225], v[224:225], v[228:229]
    v_pk_mul_f32 v[226:227], v[226:227], v[230:231]
    v_pk_mul_f32 v[232:233], v[232:233], v[236:237]
    v_pk_mul_f32 v[234:235], v[234:235], v[238:239]
    v_pk_fma_f32 v[104:105], v[104:105], v[90:91], v[90:91] op_sel:[0,1,1] op_sel_hi:[1,1,1]
    v_pk_fma_f32 v[106:107], v[106:107], v[90:91], v[90:91] op_sel:[0,1,1] op_sel_hi:[1,1,1]
    v_pk_fma_f32 v[108:109], v[108:109], v[90:91], v[90:91] op_sel:[0,1,1] op_sel_hi:[1,1,1]
    v_pk_fma_f32 v[110:111], v[110:111], v[90:91], v[90:91] op_sel:[0,1,1] op_sel_hi:[1,1,1]
    v_mfma_f32_16x16x32_bf16 v[184:187], v[120:123], v[68:71], v[184:187]
    v_rcp_f32 v104, v104
    v_rcp_f32 v105, v105
    v_mfma_f32_16x16x32_bf16 v[188:191], v[124:127], v[68:71], v[188:191]
    v_rcp_f32 v106, v106
    v_rcp_f32 v107, v107
    v_rcp_f32 v108, v108
    v_rcp_f32 v109, v109
    v_rcp_f32 v110, v110
    v_rcp_f32 v111, v111
    v_pk_mul_f32 v[224:225], v[224:225], v[104:105]
    v_pk_mul_f32 v[226:227], v[226:227], v[106:107]
    v_pk_mul_f32 v[232:233], v[232:233], v[108:109]
    v_pk_mul_f32 v[234:235], v[234:235], v[110:111]
    v_cvt_pk_bf16_f32 v228, v224, v225
    v_cvt_pk_bf16_f32 v229, v226, v227
    v_cvt_pk_bf16_f32 v230, v232, v233
    v_cvt_pk_bf16_f32 v231, v234, v235
    buffer_store_dwordx4 v[228:231], v8, s[40:43], s64 offen offset:3072 sc1
    s_add_u32 s64, s64, 3670016
    v_pk_mul_f32 v[96:97], v[144:145], v[144:145]
    v_pk_mul_f32 v[98:99], v[146:147], v[146:147]
    v_pk_mul_f32 v[100:101], v[152:153], v[152:153]
    v_pk_mul_f32 v[102:103], v[154:155], v[154:155]
    v_pk_fma_f32 v[96:97], v[96:97], v[80:81], v[80:81] op_sel:[0,0,1] op_sel_hi:[1,0,1]
    v_pk_fma_f32 v[98:99], v[98:99], v[80:81], v[80:81] op_sel:[0,0,1] op_sel_hi:[1,0,1]
    v_pk_fma_f32 v[100:101], v[100:101], v[80:81], v[80:81] op_sel:[0,0,1] op_sel_hi:[1,0,1]
    v_pk_fma_f32 v[102:103], v[102:103], v[80:81], v[80:81] op_sel:[0,0,1] op_sel_hi:[1,0,1]
    v_pk_mul_f32 v[96:97], v[96:97], v[144:145]
    v_pk_mul_f32 v[98:99], v[98:99], v[146:147]
    v_pk_mul_f32 v[100:101], v[100:101], v[152:153]
    v_pk_mul_f32 v[102:103], v[102:103], v[154:155]
    v_mfma_f32_16x16x32_bf16 v[208:211], v[112:115], v[72:75], v[208:211]
    v_exp_f32 v96, v96
    v_exp_f32 v97, v97
    v_mfma_f32_16x16x32_bf16 v[212:215], v[116:119], v[72:75], v[212:215]
    v_exp_f32 v98, v98
    v_exp_f32 v99, v99
    v_exp_f32 v100, v100
    v_exp_f32 v101, v101
    v_exp_f32 v102, v102
    v_exp_f32 v103, v103
    v_pk_mul_f32 v[144:145], v[144:145], v[148:149]
    v_pk_mul_f32 v[146:147], v[146:147], v[150:151]
    v_pk_mul_f32 v[152:153], v[152:153], v[156:157]
    v_pk_mul_f32 v[154:155], v[154:155], v[158:159]
    v_pk_fma_f32 v[96:97], v[96:97], v[88:89], v[88:89] op_sel:[0,0,0] op_sel_hi:[1,0,0]
    v_pk_fma_f32 v[98:99], v[98:99], v[88:89], v[88:89] op_sel:[0,0,0] op_sel_hi:[1,0,0]
    v_pk_fma_f32 v[100:101], v[100:101], v[88:89], v[88:89] op_sel:[0,0,0] op_sel_hi:[1,0,0]
    v_pk_fma_f32 v[102:103], v[102:103], v[88:89], v[88:89] op_sel:[0,0,0] op_sel_hi:[1,0,0]
    v_mfma_f32_16x16x32_bf16 v[216:219], v[120:123], v[72:75], v[216:219]
    v_rcp_f32 v96, v96
    v_rcp_f32 v97, v97
    v_mfma_f32_16x16x32_bf16 v[220:223], v[124:127], v[72:75], v[220:223]
    v_rcp_f32 v98, v98
    v_rcp_f32 v99, v99
    v_rcp_f32 v100, v100
    v_rcp_f32 v101, v101
    v_rcp_f32 v102, v102
    v_rcp_f32 v103, v103
    v_pk_mul_f32 v[144:145], v[144:145], v[96:97]
    v_pk_mul_f32 v[146:147], v[146:147], v[98:99]
    v_pk_mul_f32 v[152:153], v[152:153], v[100:101]
    v_pk_mul_f32 v[154:155], v[154:155], v[102:103]
    v_cvt_pk_bf16_f32 v148, v144, v145
    v_cvt_pk_bf16_f32 v149, v146, v147
    v_cvt_pk_bf16_f32 v150, v152, v153
    v_cvt_pk_bf16_f32 v151, v154, v155
    buffer_store_dwordx4 v[148:151], v8, s[40:43], s64 offen offset:0 sc1
    v_pk_mul_f32 v[104:105], v[176:177], v[176:177]
    v_pk_mul_f32 v[106:107], v[178:179], v[178:179]
    v_pk_mul_f32 v[108:109], v[184:185], v[184:185]
    v_pk_mul_f32 v[110:111], v[186:187], v[186:187]
    v_pk_fma_f32 v[104:105], v[104:105], v[82:83], v[82:83] op_sel:[0,0,1] op_sel_hi:[1,0,1]
    v_pk_fma_f32 v[106:107], v[106:107], v[82:83], v[82:83] op_sel:[0,0,1] op_sel_hi:[1,0,1]
    v_pk_fma_f32 v[108:109], v[108:109], v[82:83], v[82:83] op_sel:[0,0,1] op_sel_hi:[1,0,1]
    v_pk_fma_f32 v[110:111], v[110:111], v[82:83], v[82:83] op_sel:[0,0,1] op_sel_hi:[1,0,1]
    v_pk_mul_f32 v[104:105], v[104:105], v[176:177]
    v_pk_mul_f32 v[106:107], v[106:107], v[178:179]
    v_pk_mul_f32 v[108:109], v[108:109], v[184:185]
    v_pk_mul_f32 v[110:111], v[110:111], v[186:187]
    v_mfma_f32_16x16x32_bf16 v[240:243], v[112:115], v[76:79], v[240:243]
    v_exp_f32 v104, v104
    v_exp_f32 v105, v105
    v_mfma_f32_16x16x32_bf16 v[244:247], v[116:119], v[76:79], v[244:247]
    v_exp_f32 v106, v106
    v_exp_f32 v107, v107
    v_exp_f32 v108, v108
    v_exp_f32 v109, v109
    v_exp_f32 v110, v110
    v_exp_f32 v111, v111
    v_pk_mul_f32 v[176:177], v[176:177], v[180:181]
    v_pk_mul_f32 v[178:179], v[178:179], v[182:183]
    v_pk_mul_f32 v[184:185], v[184:185], v[188:189]
    v_pk_mul_f32 v[186:187], v[186:187], v[190:191]
    v_pk_fma_f32 v[104:105], v[104:105], v[88:89], v[88:89] op_sel:[0,1,1] op_sel_hi:[1,1,1]
    v_pk_fma_f32 v[106:107], v[106:107], v[88:89], v[88:89] op_sel:[0,1,1] op_sel_hi:[1,1,1]
    v_pk_fma_f32 v[108:109], v[108:109], v[88:89], v[88:89] op_sel:[0,1,1] op_sel_hi:[1,1,1]
    v_pk_fma_f32 v[110:111], v[110:111], v[88:89], v[88:89] op_sel:[0,1,1] op_sel_hi:[1,1,1]
    v_mfma_f32_16x16x32_bf16 v[248:251], v[120:123], v[76:79], v[248:251]
    v_rcp_f32 v104, v104
    v_rcp_f32 v105, v105
    v_mfma_f32_16x16x32_bf16 v[252:255], v[124:127], v[76:79], v[252:255]
    v_rcp_f32 v106, v106
    v_rcp_f32 v107, v107
    v_rcp_f32 v108, v108
    v_rcp_f32 v109, v109
    v_rcp_f32 v110, v110
    v_rcp_f32 v111, v111
    v_pk_mul_f32 v[176:177], v[176:177], v[104:105]
    v_pk_mul_f32 v[178:179], v[178:179], v[106:107]
    v_pk_mul_f32 v[184:185], v[184:185], v[108:109]
    v_pk_mul_f32 v[186:187], v[186:187], v[110:111]
    v_cvt_pk_bf16_f32 v180, v176, v177
    v_cvt_pk_bf16_f32 v181, v178, v179
    v_cvt_pk_bf16_f32 v182, v184, v185
    v_cvt_pk_bf16_f32 v183, v186, v187
    buffer_store_dwordx4 v[180:183], v8, s[40:43], s64 offen offset:1024 sc1
    v_pk_mul_f32 v[96:97], v[208:209], v[208:209]
    v_pk_mul_f32 v[98:99], v[210:211], v[210:211]
    v_pk_mul_f32 v[100:101], v[216:217], v[216:217]
    v_pk_mul_f32 v[102:103], v[218:219], v[218:219]
    v_pk_fma_f32 v[96:97], v[96:97], v[84:85], v[84:85] op_sel:[0,0,1] op_sel_hi:[1,0,1]
    v_pk_fma_f32 v[98:99], v[98:99], v[84:85], v[84:85] op_sel:[0,0,1] op_sel_hi:[1,0,1]
    v_pk_fma_f32 v[100:101], v[100:101], v[84:85], v[84:85] op_sel:[0,0,1] op_sel_hi:[1,0,1]
    v_pk_fma_f32 v[102:103], v[102:103], v[84:85], v[84:85] op_sel:[0,0,1] op_sel_hi:[1,0,1]
    v_pk_mul_f32 v[96:97], v[96:97], v[208:209]
    v_pk_mul_f32 v[98:99], v[98:99], v[210:211]
    v_pk_mul_f32 v[100:101], v[100:101], v[216:217]
    v_pk_mul_f32 v[102:103], v[102:103], v[218:219]
    v_exp_f32 v96, v96
    v_exp_f32 v97, v97
    v_exp_f32 v98, v98
    v_exp_f32 v99, v99
    v_exp_f32 v100, v100
    v_exp_f32 v101, v101
    v_exp_f32 v102, v102
    v_exp_f32 v103, v103
    v_pk_mul_f32 v[208:209], v[208:209], v[212:213]
    v_pk_mul_f32 v[210:211], v[210:211], v[214:215]
    v_pk_mul_f32 v[216:217], v[216:217], v[220:221]
    v_pk_mul_f32 v[218:219], v[218:219], v[222:223]
    v_pk_fma_f32 v[96:97], v[96:97], v[90:91], v[90:91] op_sel:[0,0,0] op_sel_hi:[1,0,0]
    v_pk_fma_f32 v[98:99], v[98:99], v[90:91], v[90:91] op_sel:[0,0,0] op_sel_hi:[1,0,0]
    v_pk_fma_f32 v[100:101], v[100:101], v[90:91], v[90:91] op_sel:[0,0,0] op_sel_hi:[1,0,0]
    v_pk_fma_f32 v[102:103], v[102:103], v[90:91], v[90:91] op_sel:[0,0,0] op_sel_hi:[1,0,0]
    v_rcp_f32 v96, v96
    v_rcp_f32 v97, v97
    v_rcp_f32 v98, v98
    v_rcp_f32 v99, v99
    v_rcp_f32 v100, v100
    v_rcp_f32 v101, v101
    v_rcp_f32 v102, v102
    v_rcp_f32 v103, v103
    v_pk_mul_f32 v[208:209], v[208:209], v[96:97]
    v_pk_mul_f32 v[210:211], v[210:211], v[98:99]
    v_pk_mul_f32 v[216:217], v[216:217], v[100:101]
    v_pk_mul_f32 v[218:219], v[218:219], v[102:103]
    v_cvt_pk_bf16_f32 v212, v208, v209
    v_cvt_pk_bf16_f32 v213, v210, v211
    v_cvt_pk_bf16_f32 v214, v216, v217
    v_cvt_pk_bf16_f32 v215, v218, v219
    buffer_store_dwordx4 v[212:215], v8, s[40:43], s64 offen offset:2048 sc1
    s_waitcnt vmcnt(3)
    v_mov_b32 v4, s70
    v_mov_b32 v5, s71
    v_mov_b32 v6, 0
    s_mov_b64 exec, 1
    buffer_store_dwordx2 v[4:5], v6, s[40:43], s76 offen sc1
    s_mov_b64 exec, -1
    s_add_u32 s76, s76, 262144
    v_pk_mul_f32 v[104:105], v[240:241], v[240:241]
    v_pk_mul_f32 v[106:107], v[242:243], v[242:243]
    v_pk_mul_f32 v[108:109], v[248:249], v[248:249]
    v_pk_mul_f32 v[110:111], v[250:251], v[250:251]
    v_pk_fma_f32 v[104:105], v[104:105], v[86:87], v[86:87] op_sel:[0,0,1] op_sel_hi:[1,0,1]
    v_pk_fma_f32 v[106:107], v[106:107], v[86:87], v[86:87] op_sel:[0,0,1] op_sel_hi:[1,0,1]
    v_pk_fma_f32 v[108:109], v[108:109], v[86:87], v[86:87] op_sel:[0,0,1] op_sel_hi:[1,0,1]
    v_pk_fma_f32 v[110:111], v[110:111], v[86:87], v[86:87] op_sel:[0,0,1] op_sel_hi:[1,0,1]
    v_pk_mul_f32 v[104:105], v[104:105], v[240:241]
    v_pk_mul_f32 v[106:107], v[106:107], v[242:243]
    v_pk_mul_f32 v[108:109], v[108:109], v[248:249]
    v_pk_mul_f32 v[110:111], v[110:111], v[250:251]
    v_exp_f32 v104, v104
    v_exp_f32 v105, v105
    v_exp_f32 v106, v106
    v_exp_f32 v107, v107
    v_exp_f32 v108, v108
    v_exp_f32 v109, v109
    v_exp_f32 v110, v110
    v_exp_f32 v111, v111
    v_pk_mul_f32 v[240:241], v[240:241], v[244:245]
    v_pk_mul_f32 v[242:243], v[242:243], v[246:247]
    v_pk_mul_f32 v[248:249], v[248:249], v[252:253]
    v_pk_mul_f32 v[250:251], v[250:251], v[254:255]
    v_pk_fma_f32 v[104:105], v[104:105], v[90:91], v[90:91] op_sel:[0,1,1] op_sel_hi:[1,1,1]
    v_pk_fma_f32 v[106:107], v[106:107], v[90:91], v[90:91] op_sel:[0,1,1] op_sel_hi:[1,1,1]
    v_pk_fma_f32 v[108:109], v[108:109], v[90:91], v[90:91] op_sel:[0,1,1] op_sel_hi:[1,1,1]
    v_pk_fma_f32 v[110:111], v[110:111], v[90:91], v[90:91] op_sel:[0,1,1] op_sel_hi:[1,1,1]
    v_rcp_f32 v104, v104
    v_rcp_f32 v105, v105
    v_rcp_f32 v106, v106
    v_rcp_f32 v107, v107
    v_rcp_f32 v108, v108
    v_rcp_f32 v109, v109
    v_rcp_f32 v110, v110
    v_rcp_f32 v111, v111
    v_pk_mul_f32 v[240:241], v[240:241], v[104:105]
    v_pk_mul_f32 v[242:243], v[242:243], v[106:107]
    v_pk_mul_f32 v[248:249], v[248:249], v[108:109]
    v_pk_mul_f32 v[250:251], v[250:251], v[110:111]
    v_cvt_pk_bf16_f32 v244, v240, v241
    v_cvt_pk_bf16_f32 v245, v242, v243
    v_cvt_pk_bf16_f32 v246, v248, v249
    v_cvt_pk_bf16_f32 v247, v250, v251
    buffer_store_dwordx4 v[244:247], v8, s[40:43], s64 offen offset:3072 sc1
    ds_read_b32 v35, v11 offset:1152
    s_branch L_CONV
L_SLOW6:
    s_mov_b32 s72, 800000
SB_22:
    ds_read_b32 v35, v11 offset:1164
    s_sub_u32 s72, s72, 1
    s_waitcnt lgkmcnt(0)
    v_readfirstlane_b32 s60, v35
    s_cmp_eq_u32 s72, 0
    s_cbranch_scc1 SB_22_D
    s_cmp_lt_u32 s60, 4
    s_cbranch_scc1 SB_22
SB_22_D:
    s_branch L_BACK6
L_SLOW7:
    s_mov_b32 s72, 800000
SB_23:
    ds_read_b32 v35, v11 offset:1180
    s_sub_u32 s72, s72, 1
    s_waitcnt lgkmcnt(0)
    v_readfirstlane_b32 s60, v35
    s_cmp_eq_u32 s72, 0
    s_cbranch_scc1 SB_23_D
    s_cmp_lt_u32 s60, 4
    s_cbranch_scc1 SB_23
SB_23_D:
    s_branch L_BACK7
L_KVPOLL:
    v_mov_b32 v12, 0
    s_mov_b32 s52, s14
    s_mov_b32 s53, s15
    s_mov_b32 s54, 1024
    s_mov_b32 s55, 0x20000
    s_lshl_b32 s61, s2, 2
    s_and_b32 s62, s30, 2
    s_add_u32 s61, s61, s62
    buffer_load_ushort v14, v12, s[52:55], s61 offen
    s_mov_b32 s48, s12
    s_mov_b32 s49, s13
    s_mov_b32 s50, 2097152
    s_mov_b32 s51, 0x20000
    s_bfe_u32 s62, s30, 0x10001
    s_and_b32 s63, s30, 1
    s_mul_i32 s62, s62, 4160
    s_mul_i32 s61, s63, 4128
    s_add_u32 s61, s61, s62
    v_lshrrev_b32 v16, 2, v8
    v_add_u32 v16, s61, v16
    s_mov_b64 exec, 0xff
    ds_write_b32 v16, v12 offset:6144
    s_mov_b64 exec, -1
    s_lshl_b32 s63, s63, 11
    s_add_u32 s62, s62, s63
    s_add_u32 m0, s62, 6176
    s_and_b32 s61, s30, 3
    s_lshl_b32 s61, s61, 11
    s_lshl_b32 s60, s2, 13
    s_add_u32 s60, s60, s61
    buffer_load_dwordx4 v8, s[48:51], s60 offen offset:0 lds
    buffer_load_dwordx4 v8, s[48:51], s60 offen offset:1024 lds
    s_mov_b32 s72, 800000
SB_24:
    s_sleep 4
    ds_read_b32 v35, v12 offset:1212
    s_sub_u32 s72, s72, 1
    s_waitcnt lgkmcnt(0)
    v_readfirstlane_b32 s60, v35
    s_cmp_eq_u32 s72, 0
    s_cbranch_scc1 SB_24_D
    s_cmp_lt_u32 s60, 8
    s_cbranch_scc1 SB_24
SB_24_D:
    s_mov_b32 s72, 100000
POLL_25:
    buffer_load_dwordx2 v[72:73], v74, s[40:43], s75 offen sc1
    s_waitcnt vmcnt(0)
    v_cmp_ne_u64 vcc, s[70:71], v[72:73]
    s_cbranch_vccz POLLD_26
    s_sleep 4
    s_sub_u32 s72, s72, 1
    s_cmp_lg_u32 s72, 0
    s_cbranch_scc1 POLL_25
POLLD_26:
    s_and_b32 s61, s30, 3
    s_lshl_b32 s61, s61, 11
    s_lshl_b32 s60, s2, 13
    s_add_u32 s61, s60, s61
    s_add_u32 s61, s61, 1048576
    buffer_load_dwordx4 v[40:43], v8, s[40:43], s61 offen offset:0 sc1
    buffer_load_dwordx4 v[44:47], v8, s[40:43], s61 offen offset:1024 sc1
    v_mov_b32 v35, 1
    s_mov_b64 exec, 1
    ds_add_u32 v12, v35 offset:1196
    s_mov_b64 exec, -1
    s_mov_b32 s72, 800000
SB_27:
    ds_read_b32 v35, v12 offset:1196
    s_sub_u32 s72, s72, 1
    s_waitcnt lgkmcnt(0)
    v_readfirstlane_b32 s60, v35
    s_cmp_eq_u32 s72, 0
    s_cbranch_scc1 SB_27_D
    s_cmp_lt_u32 s60, 4
    s_cbranch_scc1 SB_27
SB_27_D:
    s_bfe_u32 s62, s30, 0x10001
    s_and_b32 s63, s30, 1
    s_mul_i32 s72, s62, 4608
    s_lshl_b32 s60, s63, 11
    s_mul_i32 s62, s62, 4160
    s_add_u32 s60, s60, s62
    v_lshl_add_u32 v26, v8, 1, s60
    ds_read_b128 v[16:19], v26 offset:6176
    ds_read_b128 v[20:23], v26 offset:6192
    ds_read_b32 v24, v26 offset:6208
    v_lshrrev_b32 v25, 2, v8
    s_lshl_b32 s60, s63, 8
    s_add_u32 s60, s60, s72
    v_add_u32 v27, s60, v25
    ds_write_b32 v27, v12 offset:59712
    v_add_u32 v25, s62, v25
    v_cmp_eq_u32 vcc, 7, v0
    s_waitcnt lgkmcnt(1)
    v_readfirstlane_b32 s60, v16
    v_alignbit_b32 v16, v17, v16, 16
    v_alignbit_b32 v17, v18, v17, 16
    v_alignbit_b32 v18, v19, v18, 16
    v_alignbit_b32 v19, v20, v19, 16
    v_alignbit_b32 v20, v21, v20, 16
    v_alignbit_b32 v21, v22, v21, 16
    v_alignbit_b32 v22, v23, v22, 16
    v_alignbit_b32 v23, v24, v23, 16
    s_lshl_b32 s60, s60, 16
    v_mov_b32 v24, s60
    ds_write_b128 v26, v[16:19] offset:47328
    ds_write_b128 v26, v[20:23] offset:47344
    v_cndmask_b32 v24, v12, v24, vcc
    s_cmp_eq_u32 s63, 0
    s_cselect_b32 exec_lo, 0xff, 0
    s_mov_b32 exec_hi, 0
    ds_write_b32 v25, v24 offset:47296
    s_mov_b64 exec, -1
    v_and_b32 v1, 15, v0
    v_lshrrev_b32 v2, 4, v0
    v_add_u32 v3, 1, v1
    v_lshrrev_b32 v3, 1, v3
    v_lshl_add_u32 v3, v2, 2, v3
    v_lshlrev_b32 v3, 2, v3
    v_and_b32 v4, 1, v1
    v_xor_b32 v4, 1, v4
    v_mul_u32_u24 v4, 41152, v4
    v_add_u32 v3, v3, v4
    s_lshr_b32 s61, s30, 1
    s_mul_i32 s60, s61, 4160
    v_add_u32 v3, s60, v3
    s_and_b32 s60, s30, 1
    s_lshl_b32 s60, s60, 8
    s_add_u32 s60, s60, 6144
    v_add_u32 v32, s60, v3
    v_lshlrev_b32 v3, 5, v1
    v_lshlrev_b32 v4, 4, v2
    v_sub_u32 v3, v4, v3
    s_mul_i32 s61, s61, 4608
    s_add_u32 s60, s60, s61
    s_add_u32 s60, s60, 49952
    v_add_u32 v33, s60, v3
    v_lshlrev_b32 v3, 3, v2
    v_add_u32 v3, v3, v1
    v_sub_u32 v7, 15, v3
    s_waitcnt vmcnt(0)
    s_bfe_u32 s62, s30, 0x10001
    s_and_b32 s63, s30, 1
    s_mul_i32 s62, s62, 4608
    s_lshl_b32 s63, s63, 11
    s_add_u32 s62, s62, s63
    v_add_u32 v16, s62, v8
    ds_write_b128 v16, v[40:43] offset:55616
    ds_write_b128 v16, v[44:47] offset:56640
    v_mov_b32 v35, 1
    s_mov_b64 exec, 1
    ds_add_u32 v12, v35 offset:1152
    s_mov_b64 exec, -1
    v_mov_b32 v35, 0
L_CONV:
    s_and_b32 s63, s30, 1
    v_mov_b32 v12, 0
    v_mov_b32 v20, v32
    v_add_u32 v21, 1024, v32
    v_add_u32 v22, 2048, v32
    v_add_u32 v23, 3072, v32
    v_mov_b32 v24, v33
    s_mov_b32 s66, s32
    v_lshrrev_b32 v116, 3, v0
    s_lshl_b32 s60, s30, 3
    v_add_u32 v116, s60, v116
    v_and_b32 v117, 7, v0
    v_lshlrev_b32 v118, 10, v116
    v_lshl_add_u32 v118, v117, 4, v118
    s_lshl_b32 s68, s37, 16
    s_lshl_b32 s60, s38, 7
    s_add_u32 s68, s68, s60
    s_add_u32 s69, s68, 32768
    buffer_load_dwordx4 v[104:107], v118, s[44:47], s68 offen
    buffer_load_dwordx4 v[108:111], v118, s[44:47], s69 offen
    v_lshlrev_b32 v119, 3, v116
    s_lshl_b32 s79, s37, 9
    s_add_u32 s79, s79, 65536
    buffer_load_dwordx2 v[112:113], v119, s[40:43], s79 offen sc1
    buffer_load_dwordx2 v[114:115], v119, s[40:43], s79 offen offset:256 sc1
    s_waitcnt lgkmcnt(0)
    v_readfirstlane_b32 s60, v35
    s_nop 0
    s_cmp_ge_u32 s60, 4
    s_cbranch_scc1 L_CVGO
    s_cmp_ge_u32 s66, 28
    s_cbranch_scc1 L_NOHF0
    s_waitcnt vmcnt(4)
    v_mov_b32 v4, s70
    v_mov_b32 v5, s71
    v_mov_b32 v6, 0
    s_mov_b64 exec, 1
    buffer_store_dwordx2 v[4:5], v6, s[40:43], s76 offen sc1
    s_mov_b64 exec, -1
L_NOHF0:
    s_mov_b32 s66, 28
    s_mov_b32 s72, 800000
SB_28:
    ds_read_b32 v16, v12 offset:1152
    s_sub_u32 s72, s72, 1
    s_waitcnt lgkmcnt(0)
    v_readfirstlane_b32 s60, v16
    s_cmp_eq_u32 s72, 0
    s_cbranch_scc1 SB_28_D
    s_cmp_lt_u32 s60, 4
    s_cbranch_scc1 SB_28
SB_28_D:
L_CVGO:
    ds_read2_b32 v[128:129], v20 offset0:0 offset1:1
    ds_read2_b32 v[130:131], v20 offset0:2 offset1:3
    ds_read_b128 v[192:195], v24 offset:3584
    ds_read2_b32 v[132:133], v20 offset0:128 offset1:129
    ds_read2_b32 v[134:135], v20 offset0:130 offset1:131
    ds_read_b128 v[196:199], v24 offset:3072
    ds_read2_b32 v[136:137], v21 offset0:0 offset1:1
    ds_read2_b32 v[138:139], v21 offset0:2 offset1:3
    ds_read_b128 v[200:203], v24 offset:2560
    ds_read2_b32 v[140:141], v21 offset0:128 offset1:129
    ds_read2_b32 v[142:143], v21 offset0:130 offset1:131
    ds_read_b128 v[204:207], v24 offset:2048
    ds_read2_b32 v[144:145], v22 offset0:0 offset1:1
    ds_read2_b32 v[146:147], v22 offset0:2 offset1:3
    ds_read_b128 v[208:211], v24 offset:1536
    ds_read2_b32 v[148:149], v22 offset0:128 offset1:129
    ds_read2_b32 v[150:151], v22 offset0:130 offset1:131
    ds_read_b128 v[212:215], v24 offset:1024
    ds_read2_b32 v[152:153], v23 offset0:0 offset1:1
    ds_read2_b32 v[154:155], v23 offset0:2 offset1:3
    ds_read_b128 v[216:219], v24 offset:512
    ds_read2_b32 v[156:157], v23 offset0:128 offset1:129
    ds_read2_b32 v[158:159], v23 offset0:130 offset1:131
    ds_read_b128 v[220:223], v24 offset:0
    v_and_b32 v4, 1, v7
    v_lshlrev_b32 v4, 4, v4
    v_lshlrev_b32 v4, v4, v14
    v_ashrrev_i32 v3, 1, v7
    v_cmp_eq_u32 vcc, 0, v3
    s_nop 1
    v_cndmask_b32 v26, v12, v4, vcc
    v_cmp_eq_u32 vcc, 1, v3
    s_nop 1
    v_cndmask_b32 v27, v12, v4, vcc
    v_cmp_eq_u32 vcc, 2, v3
    s_nop 1
    v_cndmask_b32 v28, v12, v4, vcc
    v_cmp_eq_u32 vcc, 3, v3
    s_nop 1
    v_cndmask_b32 v29, v12, v4, vcc
    s_waitcnt lgkmcnt(0)
    v_mfma_f32_16x16x32_bf16 v[32:35], v[128:131], v[192:195], 0
    ds_read2_b32 v[160:161], v20 offset0:16 offset1:17
    v_mfma_f32_16x16x32_bf16 v[36:39], v[128:131], v[196:199], 0
    ds_read2_b32 v[162:163], v20 offset0:18 offset1:19
    v_mfma_f32_16x16x32_bf16 v[36:39], v[132:135], v[192:195], v[36:39]
    ds_read_b128 v[224:227], v24 offset:3648
    v_mfma_f32_16x16x32_bf16 v[40:43], v[128:131], v[200:203], 0
    ds_read2_b32 v[164:165], v20 offset0:144 offset1:145
    v_mfma_f32_16x16x32_bf16 v[40:43], v[132:135], v[196:199], v[40:43]
    ds_read2_b32 v[166:167], v20 offset0:146 offset1:147
    v_mfma_f32_16x16x32_bf16 v[40:43], v[136:139], v[192:195], v[40:43]
    ds_read_b128 v[228:231], v24 offset:3136
    v_mfma_f32_16x16x32_bf16 v[44:47], v[128:131], v[204:207], 0
    ds_read2_b32 v[168:169], v21 offset0:16 offset1:17
    v_mfma_f32_16x16x32_bf16 v[44:47], v[132:135], v[200:203], v[44:47]
    ds_read2_b32 v[170:171], v21 offset0:18 offset1:19
    v_mfma_f32_16x16x32_bf16 v[44:47], v[136:139], v[196:199], v[44:47]
    ds_read_b128 v[232:235], v24 offset:2624
    v_mfma_f32_16x16x32_bf16 v[44:47], v[140:143], v[192:195], v[44:47]
    ds_read2_b32 v[172:173], v21 offset0:144 offset1:145
    v_mfma_f32_16x16x32_bf16 v[48:51], v[128:131], v[208:211], 0
    ds_read2_b32 v[174:175], v21 offset0:146 offset1:147
    v_mfma_f32_16x16x32_bf16 v[48:51], v[132:135], v[204:207], v[48:51]
    ds_read_b128 v[236:239], v24 offset:2112
    s_cmp_ge_u32 s66, 28
    s_cbranch_scc1 L_NOHF
    s_waitcnt vmcnt(4)
    v_mov_b32 v4, s70
    v_mov_b32 v5, s71
    v_mov_b32 v6, 0
    s_mov_b64 exec, 1
    buffer_store_dwordx2 v[4:5], v6, s[40:43], s76 offen sc1
    s_mov_b64 exec, -1
L_NOHF:
    v_mfma_f32_16x16x32_bf16 v[48:51], v[136:139], v[200:203], v[48:51]
    ds_read2_b32 v[176:177], v22 offset0:16 offset1:17
    v_mfma_f32_16x16x32_bf16 v[48:51], v[140:143], v[196:199], v[48:51]
    ds_read2_b32 v[178:179], v22 offset0:18 offset1:19
    v_mfma_f32_16x16x32_bf16 v[48:51], v[144:147], v[192:195], v[48:51]
    ds_read_b128 v[240:243], v24 offset:1600
    v_mfma_f32_16x16x32_bf16 v[52:55], v[128:131], v[212:215], 0
    ds_read2_b32 v[180:181], v22 offset0:144 offset1:145
    v_mfma_f32_16x16x32_bf16 v[52:55], v[132:135], v[208:211], v[52:55]
    ds_read2_b32 v[182:183], v22 offset0:146 offset1:147
    v_mfma_f32_16x16x32_bf16 v[52:55], v[136:139], v[204:207], v[52:55]
    ds_read_b128 v[244:247], v24 offset:1088
    v_mfma_f32_16x16x32_bf16 v[52:55], v[140:143], v[200:203], v[52:55]
    ds_read2_b32 v[184:185], v23 offset0:16 offset1:17
    v_mfma_f32_16x16x32_bf16 v[52:55], v[144:147], v[196:199], v[52:55]
    ds_read2_b32 v[186:187], v23 offset0:18 offset1:19
    v_mfma_f32_16x16x32_bf16 v[52:55], v[148:151], v[192:195], v[52:55]
    ds_read_b128 v[248:251], v24 offset:576
    v_mfma_f32_16x16x32_bf16 v[56:59], v[128:131], v[216:219], 0
    ds_read2_b32 v[188:189], v23 offset0:144 offset1:145
    v_mfma_f32_16x16x32_bf16 v[56:59], v[132:135], v[212:215], v[56:59]
    ds_read2_b32 v[190:191], v23 offset0:146 offset1:147
    v_mfma_f32_16x16x32_bf16 v[56:59], v[136:139], v[208:211], v[56:59]
    ds_read_b128 v[252:255], v24 offset:64
    v_mfma_f32_16x16x32_bf16 v[56:59], v[140:143], v[204:207], v[56:59]
    v_mfma_f32_16x16x32_bf16 v[56:59], v[144:147], v[200:203], v[56:59]
    v_mfma_f32_16x16x32_bf16 v[56:59], v[148:151], v[196:199], v[56:59]
    v_mfma_f32_16x16x32_bf16 v[56:59], v[152:155], v[192:195], v[56:59]
    v_mfma_f32_16x16x32_bf16 v[60:63], v[128:131], v[220:223], 0
    v_mfma_f32_16x16x32_bf16 v[60:63], v[132:135], v[216:219], v[60:63]
    v_mfma_f32_16x16x32_bf16 v[60:63], v[136:139], v[212:215], v[60:63]
    v_mfma_f32_16x16x32_bf16 v[60:63], v[140:143], v[208:211], v[60:63]
    v_mfma_f32_16x16x32_bf16 v[60:63], v[144:147], v[204:207], v[60:63]
    v_mfma_f32_16x16x32_bf16 v[60:63], v[148:151], v[200:203], v[60:63]
    v_mfma_f32_16x16x32_bf16 v[60:63], v[152:155], v[196:199], v[60:63]
    v_mfma_f32_16x16x32_bf16 v[60:63], v[156:159], v[192:195], v[60:63]
    s_cmp_lg_u32 s63, 0
    s_cbranch_scc1 L_NOD
    v_mfma_f32_16x16x32_bf16 v[32:35], v[26:29], v[192:195], v[32:35]
    v_mfma_f32_16x16x32_bf16 v[36:39], v[26:29], v[196:199], v[36:39]
    v_mfma_f32_16x16x32_bf16 v[40:43], v[26:29], v[200:203], v[40:43]
    v_mfma_f32_16x16x32_bf16 v[44:47], v[26:29], v[204:207], v[44:47]
    v_mfma_f32_16x16x32_bf16 v[48:51], v[26:29], v[208:211], v[48:51]
    v_mfma_f32_16x16x32_bf16 v[52:55], v[26:29], v[212:215], v[52:55]
    v_mfma_f32_16x16x32_bf16 v[56:59], v[26:29], v[216:219], v[56:59]
    v_mfma_f32_16x16x32_bf16 v[60:63], v[26:29], v[220:223], v[60:63]
L_NOD:
    s_waitcnt lgkmcnt(0)
    v_mfma_f32_16x16x32_bf16 v[32:35], v[160:163], v[224:227], v[32:35]
    ds_read2_b32 v[128:129], v20 offset0:32 offset1:33
    v_mfma_f32_16x16x32_bf16 v[36:39], v[160:163], v[228:231], v[36:39]
    ds_read2_b32 v[130:131], v20 offset0:34 offset1:35
    v_mfma_f32_16x16x32_bf16 v[36:39], v[164:167], v[224:227], v[36:39]
    ds_read_b128 v[192:195], v24 offset:3712
    v_mfma_f32_16x16x32_bf16 v[40:43], v[160:163], v[232:235], v[40:43]
    ds_read2_b32 v[132:133], v20 offset0:160 offset1:161
    v_mfma_f32_16x16x32_bf16 v[40:43], v[164:167], v[228:231], v[40:43]
    ds_read2_b32 v[134:135], v20 offset0:162 offset1:163
    v_mfma_f32_16x16x32_bf16 v[40:43], v[168:171], v[224:227], v[40:43]
    ds_read_b128 v[196:199], v24 offset:3200
    v_mfma_f32_16x16x32_bf16 v[44:47], v[160:163], v[236:239], v[44:47]
    ds_read2_b32 v[136:137], v21 offset0:32 offset1:33
    v_mfma_f32_16x16x32_bf16 v[44:47], v[164:167], v[232:235], v[44:47]
    ds_read2_b32 v[138:139], v21 offset0:34 offset1:35
    v_mfma_f32_16x16x32_bf16 v[44:47], v[168:171], v[228:231], v[44:47]
    ds_read_b128 v[200:203], v24 offset:2688
    v_mfma_f32_16x16x32_bf16 v[44:47], v[172:175], v[224:227], v[44:47]
    ds_read2_b32 v[140:141], v21 offset0:160 offset1:161
    v_mfma_f32_16x16x32_bf16 v[48:51], v[160:163], v[240:243], v[48:51]
    ds_read2_b32 v[142:143], v21 offset0:162 offset1:163
    v_mfma_f32_16x16x32_bf16 v[48:51], v[164:167], v[236:239], v[48:51]
    ds_read_b128 v[204:207], v24 offset:2176
    v_mfma_f32_16x16x32_bf16 v[48:51], v[168:171], v[232:235], v[48:51]
    ds_read2_b32 v[144:145], v22 offset0:32 offset1:33
    v_mfma_f32_16x16x32_bf16 v[48:51], v[172:175], v[228:231], v[48:51]
    ds_read2_b32 v[146:147], v22 offset0:34 offset1:35
    v_mfma_f32_16x16x32_bf16 v[48:51], v[176:179], v[224:227], v[48:51]
    ds_read_b128 v[208:211], v24 offset:1664
    v_mfma_f32_16x16x32_bf16 v[52:55], v[160:163], v[244:247], v[52:55]
    ds_read2_b32 v[148:149], v22 offset0:160 offset1:161
    v_mfma_f32_16x16x32_bf16 v[52:55], v[164:167], v[240:243], v[52:55]
    ds_read2_b32 v[150:151], v22 offset0:162 offset1:163
    v_mfma_f32_16x16x32_bf16 v[52:55], v[168:171], v[236:239], v[52:55]
    ds_read_b128 v[212:215], v24 offset:1152
    v_mfma_f32_16x16x32_bf16 v[52:55], v[172:175], v[232:235], v[52:55]
    ds_read2_b32 v[152:153], v23 offset0:32 offset1:33
    v_mfma_f32_16x16x32_bf16 v[52:55], v[176:179], v[228:231], v[52:55]
    ds_read2_b32 v[154:155], v23 offset0:34 offset1:35
    v_mfma_f32_16x16x32_bf16 v[52:55], v[180:183], v[224:227], v[52:55]
    ds_read_b128 v[216:219], v24 offset:640
    v_mfma_f32_16x16x32_bf16 v[56:59], v[160:163], v[248:251], v[56:59]
    ds_read2_b32 v[156:157], v23 offset0:160 offset1:161
    v_mfma_f32_16x16x32_bf16 v[56:59], v[164:167], v[244:247], v[56:59]
    ds_read2_b32 v[158:159], v23 offset0:162 offset1:163
    v_mfma_f32_16x16x32_bf16 v[56:59], v[168:171], v[240:243], v[56:59]
    ds_read_b128 v[220:223], v24 offset:128
    v_mfma_f32_16x16x32_bf16 v[56:59], v[172:175], v[236:239], v[56:59]
    v_mfma_f32_16x16x32_bf16 v[56:59], v[176:179], v[232:235], v[56:59]
    v_mfma_f32_16x16x32_bf16 v[56:59], v[180:183], v[228:231], v[56:59]
    v_mfma_f32_16x16x32_bf16 v[56:59], v[184:187], v[224:227], v[56:59]
    v_mfma_f32_16x16x32_bf16 v[60:63], v[160:163], v[252:255], v[60:63]
    v_mfma_f32_16x16x32_bf16 v[60:63], v[164:167], v[248:251], v[60:63]
    v_mfma_f32_16x16x32_bf16 v[60:63], v[168:171], v[244:247], v[60:63]
    v_mfma_f32_16x16x32_bf16 v[60:63], v[172:175], v[240:243], v[60:63]
    v_mfma_f32_16x16x32_bf16 v[60:63], v[176:179], v[236:239], v[60:63]
    v_mfma_f32_16x16x32_bf16 v[60:63], v[180:183], v[232:235], v[60:63]
    v_mfma_f32_16x16x32_bf16 v[60:63], v[184:187], v[228:231], v[60:63]
    v_mfma_f32_16x16x32_bf16 v[60:63], v[188:191], v[224:227], v[60:63]
    s_waitcnt lgkmcnt(0)
    v_mfma_f32_16x16x32_bf16 v[32:35], v[128:131], v[192:195], v[32:35]
    ds_read2_b32 v[160:161], v20 offset0:48 offset1:49
    v_mfma_f32_16x16x32_bf16 v[36:39], v[128:131], v[196:199], v[36:39]
    ds_read2_b32 v[162:163], v20 offset0:50 offset1:51
    v_mfma_f32_16x16x32_bf16 v[36:39], v[132:135], v[192:195], v[36:39]
    ds_read_b128 v[224:227], v24 offset:3776
    v_mfma_f32_16x16x32_bf16 v[40:43], v[128:131], v[200:203], v[40:43]
    ds_read2_b32 v[164:165], v20 offset0:176 offset1:177
    v_mfma_f32_16x16x32_bf16 v[40:43], v[132:135], v[196:199], v[40:43]
    ds_read2_b32 v[166:167], v20 offset0:178 offset1:179
    v_mfma_f32_16x16x32_bf16 v[40:43], v[136:139], v[192:195], v[40:43]
    ds_read_b128 v[228:231], v24 offset:3264
    v_mfma_f32_16x16x32_bf16 v[44:47], v[128:131], v[204:207], v[44:47]
    ds_read2_b32 v[168:169], v21 offset0:48 offset1:49
    v_mfma_f32_16x16x32_bf16 v[44:47], v[132:135], v[200:203], v[44:47]
    ds_read2_b32 v[170:171], v21 offset0:50 offset1:51
    v_mfma_f32_16x16x32_bf16 v[44:47], v[136:139], v[196:199], v[44:47]
    ds_read_b128 v[232:235], v24 offset:2752
    v_mfma_f32_16x16x32_bf16 v[44:47], v[140:143], v[192:195], v[44:47]
    ds_read2_b32 v[172:173], v21 offset0:176 offset1:177
    v_mfma_f32_16x16x32_bf16 v[48:51], v[128:131], v[208:211], v[48:51]
    ds_read2_b32 v[174:175], v21 offset0:178 offset1:179
    v_mfma_f32_16x16x32_bf16 v[48:51], v[132:135], v[204:207], v[48:51]
    ds_read_b128 v[236:239], v24 offset:2240
    v_mfma_f32_16x16x32_bf16 v[48:51], v[136:139], v[200:203], v[48:51]
    ds_read2_b32 v[176:177], v22 offset0:48 offset1:49
    v_mfma_f32_16x16x32_bf16 v[48:51], v[140:143], v[196:199], v[48:51]
    ds_read2_b32 v[178:179], v22 offset0:50 offset1:51
    v_mfma_f32_16x16x32_bf16 v[48:51], v[144:147], v[192:195], v[48:51]
    ds_read_b128 v[240:243], v24 offset:1728
    v_mfma_f32_16x16x32_bf16 v[52:55], v[128:131], v[212:215], v[52:55]
    ds_read2_b32 v[180:181], v22 offset0:176 offset1:177
    v_mfma_f32_16x16x32_bf16 v[52:55], v[132:135], v[208:211], v[52:55]
    ds_read2_b32 v[182:183], v22 offset0:178 offset1:179
    v_mfma_f32_16x16x32_bf16 v[52:55], v[136:139], v[204:207], v[52:55]
    ds_read_b128 v[244:247], v24 offset:1216
    v_mfma_f32_16x16x32_bf16 v[52:55], v[140:143], v[200:203], v[52:55]
    ds_read2_b32 v[184:185], v23 offset0:48 offset1:49
    v_mfma_f32_16x16x32_bf16 v[52:55], v[144:147], v[196:199], v[52:55]
    ds_read2_b32 v[186:187], v23 offset0:50 offset1:51
    v_mfma_f32_16x16x32_bf16 v[52:55], v[148:151], v[192:195], v[52:55]
    ds_read_b128 v[248:251], v24 offset:704
    v_mfma_f32_16x16x32_bf16 v[56:59], v[128:131], v[216:219], v[56:59]
    ds_read2_b32 v[188:189], v23 offset0:176 offset1:177
    v_mfma_f32_16x16x32_bf16 v[56:59], v[132:135], v[212:215], v[56:59]
    ds_read2_b32 v[190:191], v23 offset0:178 offset1:179
    v_mfma_f32_16x16x32_bf16 v[56:59], v[136:139], v[208:211], v[56:59]
    ds_read_b128 v[252:255], v24 offset:192
    v_mfma_f32_16x16x32_bf16 v[56:59], v[140:143], v[204:207], v[56:59]
    v_mfma_f32_16x16x32_bf16 v[56:59], v[144:147], v[200:203], v[56:59]
    v_mfma_f32_16x16x32_bf16 v[56:59], v[148:151], v[196:199], v[56:59]
    v_mfma_f32_16x16x32_bf16 v[56:59], v[152:155], v[192:195], v[56:59]
    v_mfma_f32_16x16x32_bf16 v[60:63], v[128:131], v[220:223], v[60:63]
    v_mfma_f32_16x16x32_bf16 v[60:63], v[132:135], v[216:219], v[60:63]
    v_mfma_f32_16x16x32_bf16 v[60:63], v[136:139], v[212:215], v[60:63]
    v_mfma_f32_16x16x32_bf16 v[60:63], v[140:143], v[208:211], v[60:63]
    v_mfma_f32_16x16x32_bf16 v[60:63], v[144:147], v[204:207], v[60:63]
    v_mfma_f32_16x16x32_bf16 v[60:63], v[148:151], v[200:203], v[60:63]
    v_mfma_f32_16x16x32_bf16 v[60:63], v[152:155], v[196:199], v[60:63]
    v_mfma_f32_16x16x32_bf16 v[60:63], v[156:159], v[192:195], v[60:63]
    s_waitcnt lgkmcnt(0)
    v_mfma_f32_16x16x32_bf16 v[32:35], v[160:163], v[224:227], v[32:35]
    v_mfma_f32_16x16x32_bf16 v[36:39], v[160:163], v[228:231], v[36:39]
    v_mfma_f32_16x16x32_bf16 v[36:39], v[164:167], v[224:227], v[36:39]
    v_mfma_f32_16x16x32_bf16 v[40:43], v[160:163], v[232:235], v[40:43]
    v_mfma_f32_16x16x32_bf16 v[40:43], v[164:167], v[228:231], v[40:43]
    v_mfma_f32_16x16x32_bf16 v[40:43], v[168:171], v[224:227], v[40:43]
    v_mfma_f32_16x16x32_bf16 v[44:47], v[160:163], v[236:239], v[44:47]
    v_mfma_f32_16x16x32_bf16 v[44:47], v[164:167], v[232:235], v[44:47]
    v_mfma_f32_16x16x32_bf16 v[44:47], v[168:171], v[228:231], v[44:47]
    v_mfma_f32_16x16x32_bf16 v[44:47], v[172:175], v[224:227], v[44:47]
    v_mfma_f32_16x16x32_bf16 v[48:51], v[160:163], v[240:243], v[48:51]
    v_mfma_f32_16x16x32_bf16 v[48:51], v[164:167], v[236:239], v[48:51]
    v_mfma_f32_16x16x32_bf16 v[48:51], v[168:171], v[232:235], v[48:51]
    v_mfma_f32_16x16x32_bf16 v[48:51], v[172:175], v[228:231], v[48:51]
    v_mfma_f32_16x16x32_bf16 v[48:51], v[176:179], v[224:227], v[48:51]
    v_mfma_f32_16x16x32_bf16 v[52:55], v[160:163], v[244:247], v[52:55]
    v_mfma_f32_16x16x32_bf16 v[52:55], v[164:167], v[240:243], v[52:55]
    v_mfma_f32_16x16x32_bf16 v[52:55], v[168:171], v[236:239], v[52:55]
    v_mfma_f32_16x16x32_bf16 v[52:55], v[172:175], v[232:235], v[52:55]
    v_mfma_f32_16x16x32_bf16 v[52:55], v[176:179], v[228:231], v[52:55]
    v_mfma_f32_16x16x32_bf16 v[52:55], v[180:183], v[224:227], v[52:55]
    v_mfma_f32_16x16x32_bf16 v[56:59], v[160:163], v[248:251], v[56:59]
    v_mfma_f32_16x16x32_bf16 v[56:59], v[164:167], v[244:247], v[56:59]
    v_mfma_f32_16x16x32_bf16 v[56:59], v[168:171], v[240:243], v[56:59]
    v_mfma_f32_16x16x32_bf16 v[56:59], v[172:175], v[236:239], v[56:59]
    v_mfma_f32_16x16x32_bf16 v[56:59], v[176:179], v[232:235], v[56:59]
    v_mfma_f32_16x16x32_bf16 v[56:59], v[180:183], v[228:231], v[56:59]
    v_mfma_f32_16x16x32_bf16 v[56:59], v[184:187], v[224:227], v[56:59]
    v_mfma_f32_16x16x32_bf16 v[60:63], v[160:163], v[252:255], v[60:63]
    v_mfma_f32_16x16x32_bf16 v[60:63], v[164:167], v[248:251], v[60:63]
    v_mfma_f32_16x16x32_bf16 v[60:63], v[168:171], v[244:247], v[60:63]
    v_mfma_f32_16x16x32_bf16 v[60:63], v[172:175], v[240:243], v[60:63]
    v_mfma_f32_16x16x32_bf16 v[60:63], v[176:179], v[236:239], v[60:63]
    v_mfma_f32_16x16x32_bf16 v[60:63], v[180:183], v[232:235], v[60:63]
    v_mfma_f32_16x16x32_bf16 v[60:63], v[184:187], v[228:231], v[60:63]
    v_mfma_f32_16x16x32_bf16 v[60:63], v[188:191], v[224:227], v[60:63]
    v_and_b32 v1, 15, v0
    v_lshrrev_b32 v2, 4, v0
    v_lshlrev_b32 v8, 4, v0
    s_lshl_b32 s60, s30, 13
    v_add_u32 v9, s60, v8
    ds_write_b128 v9, v[32:35] offset:14464
    ds_write_b128 v9, v[36:39] offset:15488
    ds_write_b128 v9, v[40:43] offset:16512
    ds_write_b128 v9, v[44:47] offset:17536
    ds_write_b128 v9, v[48:51] offset:18560
    ds_write_b128 v9, v[52:55] offset:19584
    ds_write_b128 v9, v[56:59] offset:20608
    ds_write_b128 v9, v[60:63] offset:21632
    s_waitcnt lgkmcnt(0)
    v_mov_b32 v10, 1
    s_mov_b64 exec, 1
    ds_add_u32 v12, v10 offset:1156
    s_mov_b64 exec, -1
    v_lshrrev_b32 v3, 2, v1
    v_lshlrev_b32 v3, 16, v3
    v_and_b32 v4, 3, v1
    v_lshl_add_u32 v3, v4, 6, v3
    v_lshl_add_u32 v3, v2, 4, v3
    s_lshl_b32 s64, s30, 19
    s_lshl_b32 s61, s2, 8
    s_add_u32 s64, s64, s61
    s_add_u32 s64, s64, 3145728
    s_add_u32 s65, s64, 0x40000
    s_lshl_b32 s60, s30, 11
    v_add_u32 v9, s60, v8
    s_mov_b32 s72, 800000
SB_29:
    ds_read_b32 v10, v12 offset:1156
    s_sub_u32 s72, s72, 1
    s_waitcnt lgkmcnt(0)
    v_readfirstlane_b32 s60, v10
    s_cmp_eq_u32 s72, 0
    s_cbranch_scc1 SB_29_D
    s_cmp_lt_u32 s60, 4
    s_cbranch_scc1 SB_29
SB_29_D:
    ds_read_b128 v[128:131], v9 offset:14464
    ds_read_b128 v[132:135], v9 offset:22656
    ds_read_b128 v[136:139], v9 offset:30848
    ds_read_b128 v[140:143], v9 offset:39040
    ds_read_b128 v[144:147], v9 offset:15488
    ds_read_b128 v[148:151], v9 offset:23680
    ds_read_b128 v[152:155], v9 offset:31872
    ds_read_b128 v[156:159], v9 offset:40064
    s_waitcnt lgkmcnt(4)
    v_pk_add_f32 v[128:129], v[128:129], v[132:133]
    v_pk_add_f32 v[136:137], v[136:137], v[140:141]
    v_pk_add_f32 v[130:131], v[130:131], v[134:135]
    v_pk_add_f32 v[138:139], v[138:139], v[142:143]
    v_cvt_pk_bf16_f32 v64, v128, v136
    v_cvt_pk_bf16_f32 v65, v129, v137
    v_cvt_pk_bf16_f32 v66, v130, v138
    v_cvt_pk_bf16_f32 v67, v131, v139
    buffer_store_dwordx4 v[64:67], v3, s[40:43], s64 offen sc1
    s_waitcnt lgkmcnt(0)
    v_pk_add_f32 v[144:145], v[144:145], v[148:149]
    v_pk_add_f32 v[152:153], v[152:153], v[156:157]
    v_pk_add_f32 v[146:147], v[146:147], v[150:151]
    v_pk_add_f32 v[154:155], v[154:155], v[158:159]
    v_cvt_pk_bf16_f32 v68, v144, v152
    v_cvt_pk_bf16_f32 v69, v145, v153
    v_cvt_pk_bf16_f32 v70, v146, v154
    v_cvt_pk_bf16_f32 v71, v147, v155
    buffer_store_dwordx4 v[68:71], v3, s[40:43], s65 offen sc1
    s_lshl_b32 s60, s30, 15
    s_lshl_b32 s61, s2, 7
    s_add_u32 s60, s60, s61
    s_add_u32 s60, s60, 786432
    s_waitcnt vmcnt(0)
    v_mov_b32 v4, s70
    v_mov_b32 v5, s71
    v_mov_b32 v6, 0
    s_mov_b64 exec, 1
    buffer_store_dwordx2 v[4:5], v6, s[40:43], s60 offen sc1
    s_mov_b64 exec, -1
    s_waitcnt vmcnt(1)
    s_mov_b32 s72, 100000
ST_30:
    v_cmp_ne_u32 vcc, s70, v113
    v_cmp_ne_u32 s[64:65], s70, v115
    s_nop 0
    s_or_b64 vcc, vcc, s[64:65]
    s_cbranch_scc0 STD_31
    s_sleep 4
    buffer_load_dwordx2 v[112:113], v119, s[40:43], s79 offen sc1
    buffer_load_dwordx2 v[114:115], v119, s[40:43], s79 offen offset:256 sc1
    s_waitcnt vmcnt(0)
    s_sub_u32 s72, s72, 1
    s_cmp_lg_u32 s72, 0
    s_cbranch_scc1 ST_30
STD_31:
    v_lshlrev_b32 v30, 16, v112
    v_and_b32 v31, 0xffff0000, v112
    v_rcp_f32 v31, v31
    v_lshlrev_b32 v32, 16, v104
    v_and_b32 v33, 0xffff0000, v104
    v_sub_f32 v40, v32, v30
    v_sub_f32 v41, v33, v30
    v_mul_f32 v40, v40, v31
    v_mul_f32 v41, v41, v31
    v_lshlrev_b32 v34, 16, v105
    v_and_b32 v35, 0xffff0000, v105
    v_sub_f32 v42, v34, v30
    v_sub_f32 v43, v35, v30
    v_mul_f32 v42, v42, v31
    v_mul_f32 v43, v43, v31
    v_lshlrev_b32 v36, 16, v106
    v_and_b32 v37, 0xffff0000, v106
    v_sub_f32 v44, v36, v30
    v_sub_f32 v45, v37, v30
    v_mul_f32 v44, v44, v31
    v_mul_f32 v45, v45, v31
    v_lshlrev_b32 v38, 16, v107
    v_and_b32 v39, 0xffff0000, v107
    v_sub_f32 v46, v38, v30
    v_sub_f32 v47, v39, v30
    v_mul_f32 v46, v46, v31
    v_mul_f32 v47, v47, v31
    v_lshlrev_b32 v30, 16, v114
    v_and_b32 v31, 0xffff0000, v114
    v_rcp_f32 v31, v31
    v_lshlrev_b32 v48, 16, v108
    v_and_b32 v49, 0xffff0000, v108
    v_sub_f32 v56, v48, v30
    v_sub_f32 v57, v49, v30
    v_mul_f32 v56, v56, v31
    v_mul_f32 v57, v57, v31
    v_lshlrev_b32 v50, 16, v109
    v_and_b32 v51, 0xffff0000, v109
    v_sub_f32 v58, v50, v30
    v_sub_f32 v59, v51, v30
    v_mul_f32 v58, v58, v31
    v_mul_f32 v59, v59, v31
    v_lshlrev_b32 v52, 16, v110
    v_and_b32 v53, 0xffff0000, v110
    v_sub_f32 v60, v52, v30
    v_sub_f32 v61, v53, v30
    v_mul_f32 v60, v60, v31
    v_mul_f32 v61, v61, v31
    v_lshlrev_b32 v54, 16, v111
    v_and_b32 v55, 0xffff0000, v111
    v_sub_f32 v62, v54, v30
    v_sub_f32 v63, v55, v30
    v_mul_f32 v62, v62, v31
    v_mul_f32 v63, v63, v31
    v_lshrrev_b32 v20, 4, v0
    v_lshlrev_b32 v20, 8, v20
    v_and_b32 v21, 15, v0
    s_lshl_b32 s60, s30, 1
    v_xor_b32 v21, s60, v21
    v_lshl_add_u32 v20, v21, 4, v20
    v_xor_b32 v21, 16, v20
    s_lshl_b32 s62, s37, 16
    s_lshl_b32 s61, s38, 13
    s_add_u32 s62, s62, s61
    s_lshl_b32 s61, s30, 11
    s_add_u32 s62, s62, s61
    s_add_u32 s62, s62, 3145728
    s_add_u32 s63, s61, 47360
    v_lshrrev_b32 v22, 2, v116
    v_xor_b32 v22, v22, v117
    v_lshlrev_b32 v22, 4, v22
    v_lshl_add_u32 v22, v117, 10, v22
    v_and_b32 v23, 3, v116
    v_lshl_add_u32 v22, v23, 2, v22
    v_add_u32 v22, 47360, v22
    v_and_b32 v4, 7, v0
    v_lshlrev_b32 v4, 7, v4
    s_lshr_b32 s66, s37, 3
    s_lshl_b32 s66, s66, 15
    s_lshl_b32 s61, s38, 12
    s_add_u32 s66, s66, s61
    s_lshl_b32 s61, s30, 10
    s_add_u32 s66, s66, s61
    s_add_u32 s66, s66, 786432
    s_mov_b32 s72, 800000
SB_32:
    s_sleep 2
    ds_read_b32 v10, v12 offset:1160
    s_sub_u32 s72, s72, 1
    s_waitcnt lgkmcnt(0)
    v_readfirstlane_b32 s60, v10
    s_cmp_eq_u32 s72, 0
    s_cbranch_scc1 SB_32_D
    s_cmp_lt_u32 s60, 4
    s_cbranch_scc1 SB_32
SB_32_D:
    s_mov_b32 s72, 100000
POLL_33:
    buffer_load_dwordx2 v[6:7], v4, s[40:43], s66 offen sc1
    s_waitcnt vmcnt(0)
    v_cmp_ne_u64 vcc, s[70:71], v[6:7]
    s_cbranch_vccz POLLD_34
    s_sleep 6
    s_sub_u32 s72, s72, 1
    s_cmp_lg_u32 s72, 0
    s_cbranch_scc1 POLL_33
POLLD_34:
    s_mov_b32 m0, s63
    s_nop 0
    buffer_load_dwordx4 v20, s[40:43], s62 offen sc1 lds
    buffer_load_dwordx4 v21, s[40:43], s62 offen offset:1024 sc1 lds
    v_and_b32 v4, 7, v116
    v_lshlrev_b32 v5, 1, v117
    v_xor_b32 v4, v4, v5
    v_lshlrev_b32 v4, 4, v4
    v_lshl_add_u32 v4, v116, 8, v4
    v_add_u32 v4, 65536, v4
    v_xor_b32 v5, 16, v4
    v_add_u32 v6, 49152, v4
    v_add_u32 v7, 49152, v5
    s_mov_b32 s48, s24
    s_mov_b32 s49, s25
    s_mov_b32 s50, 2097152
    s_mov_b32 s51, 0x20000
    s_waitcnt vmcnt(0) lgkmcnt(0)
    s_barrier
    ds_read2_b32 v[80:81], v22 offset0:0 offset1:32
    ds_read2_b32 v[82:83], v22 offset0:64 offset1:96
    ds_read2_b32 v[84:85], v22 offset0:128 offset1:160
    ds_read2_b32 v[86:87], v22 offset0:192 offset1:224
    ds_read_b128 v[128:131], v4 offset:0
    ds_read_b128 v[132:135], v5 offset:0
    ds_read_b128 v[136:139], v4 offset:12288
    ds_read_b128 v[140:143], v5 offset:12288
    ds_read_b128 v[144:147], v4 offset:24576
    ds_read_b128 v[148:151], v5 offset:24576
    ds_read_b128 v[152:155], v4 offset:36864
    ds_read_b128 v[156:159], v5 offset:36864
    ds_read_b128 v[160:163], v6 offset:0
    ds_read_b128 v[164:167], v7 offset:0
    s_waitcnt lgkmcnt(10)
    v_lshlrev_b32 v30, 16, v80
    v_and_b32 v31, 0xffff0000, v80
    v_pk_fma_f32 v[32:33], v[40:41], v[30:31], v[32:33]
    v_lshlrev_b32 v30, 16, v82
    v_and_b32 v31, 0xffff0000, v82
    v_pk_fma_f32 v[34:35], v[42:43], v[30:31], v[34:35]
    v_lshlrev_b32 v30, 16, v84
    v_and_b32 v31, 0xffff0000, v84
    v_pk_fma_f32 v[36:37], v[44:45], v[30:31], v[36:37]
    v_lshlrev_b32 v30, 16, v86
    v_and_b32 v31, 0xffff0000, v86
    v_pk_fma_f32 v[38:39], v[46:47], v[30:31], v[38:39]
    v_lshlrev_b32 v30, 16, v81
    v_and_b32 v31, 0xffff0000, v81
    v_pk_fma_f32 v[48:49], v[56:57], v[30:31], v[48:49]
    v_lshlrev_b32 v30, 16, v83
    v_and_b32 v31, 0xffff0000, v83
    v_pk_fma_f32 v[50:51], v[58:59], v[30:31], v[50:51]
    v_lshlrev_b32 v30, 16, v85
    v_and_b32 v31, 0xffff0000, v85
    v_pk_fma_f32 v[52:53], v[60:61], v[30:31], v[52:53]
    v_lshlrev_b32 v30, 16, v87
    v_and_b32 v31, 0xffff0000, v87
    v_pk_fma_f32 v[54:55], v[62:63], v[30:31], v[54:55]
    ds_read_b128 v[168:171], v6 offset:12288
    ds_read_b128 v[172:175], v7 offset:12288
    ds_read_b128 v[176:179], v6 offset:24576
    ds_read_b128 v[180:183], v7 offset:24576
    ds_read_b128 v[184:187], v6 offset:36864
    ds_read_b128 v[188:191], v7 offset:36864
    s_waitcnt lgkmcnt(8)
    v_pk_add_f32 v[32:33], v[32:33], v[128:129]
    v_pk_add_f32 v[34:35], v[34:35], v[130:131]
    v_pk_add_f32 v[36:37], v[36:37], v[132:133]
    v_pk_add_f32 v[38:39], v[38:39], v[134:135]
    v_pk_add_f32 v[32:33], v[32:33], v[136:137]
    v_pk_add_f32 v[34:35], v[34:35], v[138:139]
    v_pk_add_f32 v[36:37], v[36:37], v[140:141]
    v_pk_add_f32 v[38:39], v[38:39], v[142:143]
    v_pk_add_f32 v[32:33], v[32:33], v[144:145]
    v_pk_add_f32 v[34:35], v[34:35], v[146:147]
    v_pk_add_f32 v[36:37], v[36:37], v[148:149]
    v_pk_add_f32 v[38:39], v[38:39], v[150:151]
    v_pk_add_f32 v[32:33], v[32:33], v[152:153]
    v_pk_add_f32 v[34:35], v[34:35], v[154:155]
    v_pk_add_f32 v[36:37], v[36:37], v[156:157]
    v_pk_add_f32 v[38:39], v[38:39], v[158:159]
    v_cvt_pk_bf16_f32 v40, v32, v33
    v_cvt_pk_bf16_f32 v41, v34, v35
    v_cvt_pk_bf16_f32 v42, v36, v37
    v_cvt_pk_bf16_f32 v43, v38, v39
    buffer_store_dwordx4 v[40:43], v118, s[48:51], s68 offen
    s_waitcnt lgkmcnt(0)
    v_pk_add_f32 v[48:49], v[48:49], v[160:161]
    v_pk_add_f32 v[50:51], v[50:51], v[162:163]
    v_pk_add_f32 v[52:53], v[52:53], v[164:165]
    v_pk_add_f32 v[54:55], v[54:55], v[166:167]
    v_pk_add_f32 v[48:49], v[48:49], v[168:169]
    v_pk_add_f32 v[50:51], v[50:51], v[170:171]
    v_pk_add_f32 v[52:53], v[52:53], v[172:173]
    v_pk_add_f32 v[54:55], v[54:55], v[174:175]
    v_pk_add_f32 v[48:49], v[48:49], v[176:177]
    v_pk_add_f32 v[50:51], v[50:51], v[178:179]
    v_pk_add_f32 v[52:53], v[52:53], v[180:181]
    v_pk_add_f32 v[54:55], v[54:55], v[182:183]
    v_pk_add_f32 v[48:49], v[48:49], v[184:185]
    v_pk_add_f32 v[50:51], v[50:51], v[186:187]
    v_pk_add_f32 v[52:53], v[52:53], v[188:189]
    v_pk_add_f32 v[54:55], v[54:55], v[190:191]
    v_cvt_pk_bf16_f32 v56, v48, v49
    v_cvt_pk_bf16_f32 v57, v50, v51
    v_cvt_pk_bf16_f32 v58, v52, v53
    v_cvt_pk_bf16_f32 v59, v54, v55
    buffer_store_dwordx4 v[56:59], v118, s[48:51], s69 offen
    s_cmp_lg_u32 s2, 193
    s_cbranch_scc1 L_NORST
    s_cmp_lg_u32 s30, 0
    s_cbranch_scc1 L_NORST
    s_mov_b32 s56, s26
    s_mov_b32 s57, s27
    s_mov_b32 s58, 256
    s_mov_b32 s59, 0x20000
    v_mov_b32 v2, 0
    v_mov_b32 v3, 0
    s_mov_b64 exec, 1
    buffer_store_dwordx2 v[2:3], v2, s[56:59], 0 offen sc1
    s_mov_b64 exec, -1
L_NORST:
    s_endpgm
L_SPARE:
    s_lshr_b32 s62, s30, 2
    s_and_b32 s63, s30, 3
    v_lshrrev_b32 v1, 5, v0
    v_and_b32 v2, 31, v0
    v_lshlrev_b32 v15, 13, v1
    v_lshl_add_u32 v15, v2, 4, v15
    s_lshl_b32 s64, s3, 16
    s_lshl_b32 s60, s63, 14
    s_add_u32 s64, s64, s60
    s_lshl_b32 s60, s62, 9
    s_add_u32 s64, s64, s60
    s_add_u32 s65, s64, 4096
    s_sub_u32 s60, s64, 3072
    v_add_u32 v10, s60, v15
    s_sub_u32 s60, s64, 2048
    v_add_u32 v11, s60, v15
    s_sub_u32 s60, s64, 1024
    v_add_u32 v12, s60, v15
    v_lshlrev_b32 v9, 6, v2
    s_lshl_b32 s67, s62, 11
    v_lshlrev_b32 v8, 4, v0
    s_waitcnt lgkmcnt(0)
    s_mov_b32 s44, s4
    s_mov_b32 s45, s5
    s_mov_b32 s46, 2097152
    s_mov_b32 s47, 0x20000
    s_mov_b32 s40, s28
    s_mov_b32 s41, s29
    s_mov_b32 s42, 15728640
    s_mov_b32 s43, 0x20000
    s_mov_b32 s48, s6
    s_mov_b32 s49, s7
    s_mov_b32 s50, 2097152
    s_mov_b32 s51, 0x20000
    s_mov_b32 s52, s8
    s_mov_b32 s53, s9
    s_mov_b32 s54, 2097152
    s_mov_b32 s55, 0x20000
    s_mov_b32 s56, s10
    s_mov_b32 s57, s11
    s_mov_b32 s58, 4096
    s_mov_b32 s59, 0x20000
    v_mov_b32 v250, 0
    v_lshlrev_b32 v3, 2, v0
    ds_write_b32 v3, v250 offset:1152
    s_waitcnt lgkmcnt(0)
    s_cmp_eq_u32 s62, 0
    s_cbranch_scc1 SPB_35
    s_barrier
SPB_35:
    buffer_load_dwordx4 v[60:63], v15, s[48:51], s64 offen offset:0
    buffer_load_dwordx4 v[64:67], v15, s[48:51], s64 offen offset:1024
    buffer_load_dwordx4 v[68:71], v15, s[48:51], s64 offen offset:2048
    buffer_load_dwordx4 v[72:75], v15, s[48:51], s64 offen offset:3072
    buffer_load_dwordx4 v[76:79], v15, s[48:51], s65 offen offset:0
    buffer_load_dwordx4 v[80:83], v15, s[48:51], s65 offen offset:1024
    buffer_load_dwordx4 v[84:87], v15, s[48:51], s65 offen offset:2048
    buffer_load_dwordx4 v[88:91], v15, s[48:51], s65 offen offset:3072
    s_lshl_b32 s60, s30, 11
    s_add_u32 m0, s60, 131072
    v_add_u32 v9, m0, v9
    buffer_load_dwordx4 v8, s[56:59], s67 offen offset:0 lds
    buffer_load_dwordx4 v8, s[56:59], s67 offen offset:1024 lds
    buffer_load_dwordx4 v[48:51], v10, s[48:51], 0 offen
    buffer_load_dwordx4 v[52:55], v11, s[48:51], 0 offen
    buffer_load_dwordx4 v[56:59], v12, s[48:51], 0 offen
    buffer_load_dwordx4 v[92:95], v15, s[52:55], s64 offen offset:0
    buffer_load_dwordx4 v[96:99], v15, s[52:55], s64 offen offset:1024
    buffer_load_dwordx4 v[100:103], v15, s[52:55], s64 offen offset:2048
    buffer_load_dwordx4 v[104:107], v15, s[52:55], s64 offen offset:3072
    buffer_load_dwordx4 v[108:111], v15, s[52:55], s65 offen offset:0
    buffer_load_dwordx4 v[112:115], v15, s[52:55], s65 offen offset:1024
    buffer_load_dwordx4 v[116:119], v15, s[52:55], s65 offen offset:2048
    buffer_load_dwordx4 v[120:123], v15, s[52:55], s65 offen offset:3072
    v_bfe_u32 v13, v0, 3, 1
    v_lshlrev_b32 v13, 10, v13
    v_lshrrev_b32 v14, 4, v0
    v_lshl_add_u32 v13, v14, 7, v13
    v_and_b32 v14, 7, v0
    v_lshl_add_u32 v13, v14, 4, v13
    s_lshl_b32 s60, s31, 5
    s_add_u32 s60, s60, s32
    s_lshl_b32 s60, s60, 2
    s_and_b32 s61, s30, 3
    s_add_u32 s60, s60, s61
    s_lshl_b32 s60, s60, 11
    s_cmp_eq_u32 s62, 0
    s_cselect_b64 exec, -1, 0
    buffer_load_dwordx4 v[16:19], v13, s[44:47], s60 offen offset:0
    buffer_load_dwordx4 v[20:23], v13, s[44:47], s60 offen offset:512
    s_mov_b64 exec, -1
    s_cmp_lg_u32 s62, 0
    s_cbranch_scc1 SPB_36
    s_barrier
SPB_36:
    s_mov_b32 s56, s26
    s_mov_b32 s57, s27
    s_mov_b32 s58, 256
    s_mov_b32 s59, 0x20000
    v_mov_b32 v244, 0x3f803f80
    v_mov_b32 v245, 0x3f803f80
    v_mov_b32 v246, 0x3f803f80
    v_mov_b32 v247, 0x3f803f80
    s_lshl_b32 s60, s63, 1
    s_sub_u32 s60, 7, s60
    v_sub_u32 v1, s60, v1
    v_and_b32 v3, 7, v0
    v_xor_b32 v1, v1, v3
    v_lshlrev_b32 v1, 4, v1
    v_lshl_add_u32 v1, v2, 10, v1
    s_lshl_b32 s60, s62, 15
    s_add_u32 s60, s60, 65536
    v_add_u32 v1, s60, v1
    v_lshrrev_b32 v2, 3, v0
    v_lshlrev_b32 v6, 4, v3
    v_lshl_add_u32 v6, v2, 10, v6
    s_lshl_b32 s60, s30, 13
    s_add_u32 s60, s60, 65536
    v_add_u32 v6, s60, v6
    v_xor_b32 v3, v3, v2
    v_lshlrev_b32 v3, 4, v3
    v_lshl_add_u32 v7, v2, 15, v3
    s_lshl_b32 s66, s30, 18
    s_lshl_b32 s61, s3, 7
    s_sub_u32 s66, s66, s61
    s_add_u32 s66, s66, 1052544
    s_lshl_b32 s60, s62, 2
    v_mov_b32 v14, s60
    s_waitcnt vmcnt(10)
    ds_read_b128 v[124:127], v9 offset:0
    ds_read_b128 v[128:131], v9 offset:16
    ds_read_b128 v[132:135], v9 offset:32
    ds_read_b128 v[136:139], v9 offset:48
    v_lshlrev_b32 v140, 16, v48
    v_and_b32 v141, 0xffff0000, v48
    v_lshlrev_b32 v142, 16, v52
    v_and_b32 v143, 0xffff0000, v52
    v_lshlrev_b32 v144, 16, v56
    v_and_b32 v145, 0xffff0000, v56
    v_lshlrev_b32 v146, 16, v60
    v_and_b32 v147, 0xffff0000, v60
    v_lshlrev_b32 v148, 16, v64
    v_and_b32 v149, 0xffff0000, v64
    v_lshlrev_b32 v150, 16, v68
    v_and_b32 v151, 0xffff0000, v68
    v_lshlrev_b32 v152, 16, v72
    v_and_b32 v153, 0xffff0000, v72
    v_lshlrev_b32 v154, 16, v76
    v_and_b32 v155, 0xffff0000, v76
    v_lshlrev_b32 v156, 16, v80
    v_and_b32 v157, 0xffff0000, v80
    v_lshlrev_b32 v158, 16, v84
    v_and_b32 v159, 0xffff0000, v84
    v_lshlrev_b32 v160, 16, v88
    v_and_b32 v161, 0xffff0000, v88
    s_waitcnt lgkmcnt(0)
    v_lshlrev_b32 v178, 16, v124
    v_and_b32 v180, 0xffff0000, v124
    v_lshlrev_b32 v182, 16, v125
    v_and_b32 v184, 0xffff0000, v125
    v_lshlrev_b32 v179, 16, v126
    v_and_b32 v181, 0xffff0000, v126
    v_lshlrev_b32 v183, 16, v127
    v_and_b32 v185, 0xffff0000, v127
    v_pk_mul_f32 v[186:187], v[140:141], v[184:185]
    v_pk_mul_f32 v[188:189], v[142:143], v[184:185]
    v_pk_mul_f32 v[190:191], v[144:145], v[184:185]
    v_pk_mul_f32 v[192:193], v[146:147], v[184:185]
    v_pk_mul_f32 v[194:195], v[148:149], v[184:185]
    v_pk_mul_f32 v[196:197], v[150:151], v[184:185]
    v_pk_mul_f32 v[198:199], v[152:153], v[184:185]
    v_pk_mul_f32 v[200:201], v[154:155], v[184:185]
    v_pk_fma_f32 v[186:187], v[142:143], v[182:183], v[186:187]
    v_pk_fma_f32 v[188:189], v[144:145], v[182:183], v[188:189]
    v_pk_fma_f32 v[190:191], v[146:147], v[182:183], v[190:191]
    v_pk_fma_f32 v[192:193], v[148:149], v[182:183], v[192:193]
    v_pk_fma_f32 v[194:195], v[150:151], v[182:183], v[194:195]
    v_pk_fma_f32 v[196:197], v[152:153], v[182:183], v[196:197]
    v_pk_fma_f32 v[198:199], v[154:155], v[182:183], v[198:199]
    v_pk_fma_f32 v[200:201], v[156:157], v[182:183], v[200:201]
    v_pk_fma_f32 v[186:187], v[144:145], v[180:181], v[186:187]
    v_pk_fma_f32 v[188:189], v[146:147], v[180:181], v[188:189]
    v_pk_fma_f32 v[190:191], v[148:149], v[180:181], v[190:191]
    v_pk_fma_f32 v[192:193], v[150:151], v[180:181], v[192:193]
    v_pk_fma_f32 v[194:195], v[152:153], v[180:181], v[194:195]
    v_pk_fma_f32 v[196:197], v[154:155], v[180:181], v[196:197]
    v_pk_fma_f32 v[198:199], v[156:157], v[180:181], v[198:199]
    v_pk_fma_f32 v[200:201], v[158:159], v[180:181], v[200:201]
    v_pk_fma_f32 v[186:187], v[146:147], v[178:179], v[186:187]
    v_pk_fma_f32 v[188:189], v[148:149], v[178:179], v[188:189]
    v_pk_fma_f32 v[190:191], v[150:151], v[178:179], v[190:191]
    v_pk_fma_f32 v[192:193], v[152:153], v[178:179], v[192:193]
    v_pk_fma_f32 v[194:195], v[154:155], v[178:179], v[194:195]
    v_pk_fma_f32 v[196:197], v[156:157], v[178:179], v[196:197]
    v_pk_fma_f32 v[198:199], v[158:159], v[178:179], v[198:199]
    v_pk_fma_f32 v[200:201], v[160:161], v[178:179], v[200:201]
    s_waitcnt vmcnt(2)
    v_lshlrev_b32 v162, 16, v92
    v_and_b32 v163, 0xffff0000, v92
    v_lshlrev_b32 v164, 16, v96
    v_and_b32 v165, 0xffff0000, v96
    v_lshlrev_b32 v166, 16, v100
    v_and_b32 v167, 0xffff0000, v100
    v_lshlrev_b32 v168, 16, v104
    v_and_b32 v169, 0xffff0000, v104
    v_lshlrev_b32 v170, 16, v108
    v_and_b32 v171, 0xffff0000, v108
    v_lshlrev_b32 v172, 16, v112
    v_and_b32 v173, 0xffff0000, v112
    v_lshlrev_b32 v174, 16, v116
    v_and_b32 v175, 0xffff0000, v116
    v_lshlrev_b32 v176, 16, v120
    v_and_b32 v177, 0xffff0000, v120
    v_pk_mul_f32 v[186:187], v[186:187], v[162:163]
    v_pk_mul_f32 v[188:189], v[188:189], v[164:165]
    v_pk_mul_f32 v[190:191], v[190:191], v[166:167]
    v_pk_mul_f32 v[192:193], v[192:193], v[168:169]
    v_pk_mul_f32 v[194:195], v[194:195], v[170:171]
    v_pk_mul_f32 v[196:197], v[196:197], v[172:173]
    v_pk_mul_f32 v[198:199], v[198:199], v[174:175]
    v_pk_mul_f32 v[200:201], v[200:201], v[176:177]
    v_cvt_pk_bf16_f32 v204, v200, v198
    v_cvt_pk_bf16_f32 v205, v196, v194
    v_cvt_pk_bf16_f32 v206, v192, v190
    v_cvt_pk_bf16_f32 v207, v188, v186
    ds_write_b128 v1, v[204:207] offset:0
    v_cvt_pk_bf16_f32 v208, v201, v199
    v_cvt_pk_bf16_f32 v209, v197, v195
    v_cvt_pk_bf16_f32 v210, v193, v191
    v_cvt_pk_bf16_f32 v211, v189, v187
    ds_write_b128 v1, v[208:211] offset:128
    s_waitcnt lgkmcnt(0)
    v_mov_b32 v4, 1
    s_mov_b64 exec, 1
    ds_add_u32 v14, v4 offset:1200
    s_mov_b64 exec, -1
    v_lshlrev_b32 v140, 16, v49
    v_and_b32 v141, 0xffff0000, v49
    v_lshlrev_b32 v142, 16, v53
    v_and_b32 v143, 0xffff0000, v53
    v_lshlrev_b32 v144, 16, v57
    v_and_b32 v145, 0xffff0000, v57
    v_lshlrev_b32 v146, 16, v61
    v_and_b32 v147, 0xffff0000, v61
    v_lshlrev_b32 v148, 16, v65
    v_and_b32 v149, 0xffff0000, v65
    v_lshlrev_b32 v150, 16, v69
    v_and_b32 v151, 0xffff0000, v69
    v_lshlrev_b32 v152, 16, v73
    v_and_b32 v153, 0xffff0000, v73
    v_lshlrev_b32 v154, 16, v77
    v_and_b32 v155, 0xffff0000, v77
    v_lshlrev_b32 v156, 16, v81
    v_and_b32 v157, 0xffff0000, v81
    v_lshlrev_b32 v158, 16, v85
    v_and_b32 v159, 0xffff0000, v85
    v_lshlrev_b32 v160, 16, v89
    v_and_b32 v161, 0xffff0000, v89
    s_mov_b32 s72, 800000
SB_37:
    ds_read_b32 v4, v14 offset:1200
    s_sub_u32 s72, s72, 1
    s_waitcnt lgkmcnt(0)
    v_readfirstlane_b32 s60, v4
    s_cmp_eq_u32 s72, 0
    s_cbranch_scc1 SB_37_D
    s_cmp_lt_u32 s60, 4
    s_cbranch_scc1 SB_37
SB_37_D:
    ds_read_b128 v[220:223], v6 offset:0
    ds_read_b128 v[224:227], v6 offset:128
    v_lshlrev_b32 v178, 16, v128
    v_and_b32 v180, 0xffff0000, v128
    v_lshlrev_b32 v182, 16, v129
    v_and_b32 v184, 0xffff0000, v129
    v_lshlrev_b32 v179, 16, v130
    v_and_b32 v181, 0xffff0000, v130
    v_lshlrev_b32 v183, 16, v131
    v_and_b32 v185, 0xffff0000, v131
    v_pk_mul_f32 v[186:187], v[140:141], v[184:185]
    v_pk_mul_f32 v[188:189], v[142:143], v[184:185]
    v_pk_mul_f32 v[190:191], v[144:145], v[184:185]
    v_pk_mul_f32 v[192:193], v[146:147], v[184:185]
    v_pk_mul_f32 v[194:195], v[148:149], v[184:185]
    v_pk_mul_f32 v[196:197], v[150:151], v[184:185]
    v_pk_mul_f32 v[198:199], v[152:153], v[184:185]
    v_pk_mul_f32 v[200:201], v[154:155], v[184:185]
    buffer_load_dwordx2 v[248:249], v250, s[56:59], 0 offen sc1
    s_waitcnt lgkmcnt(1)
    buffer_store_dwordx4 v[220:223], v7, s[40:43], s66 offen sc1
    s_add_u32 s66, s66, 4096
    s_waitcnt lgkmcnt(0)
    buffer_store_dwordx4 v[224:227], v7, s[40:43], s66 offen sc1
    s_add_u32 s66, s66, 4096
    v_pk_fma_f32 v[186:187], v[142:143], v[182:183], v[186:187]
    v_pk_fma_f32 v[188:189], v[144:145], v[182:183], v[188:189]
    v_pk_fma_f32 v[190:191], v[146:147], v[182:183], v[190:191]
    v_pk_fma_f32 v[192:193], v[148:149], v[182:183], v[192:193]
    v_pk_fma_f32 v[194:195], v[150:151], v[182:183], v[194:195]
    v_pk_fma_f32 v[196:197], v[152:153], v[182:183], v[196:197]
    v_pk_fma_f32 v[198:199], v[154:155], v[182:183], v[198:199]
    v_pk_fma_f32 v[200:201], v[156:157], v[182:183], v[200:201]
    v_pk_fma_f32 v[186:187], v[144:145], v[180:181], v[186:187]
    v_pk_fma_f32 v[188:189], v[146:147], v[180:181], v[188:189]
    v_pk_fma_f32 v[190:191], v[148:149], v[180:181], v[190:191]
    v_pk_fma_f32 v[192:193], v[150:151], v[180:181], v[192:193]
    v_pk_fma_f32 v[194:195], v[152:153], v[180:181], v[194:195]
    v_pk_fma_f32 v[196:197], v[154:155], v[180:181], v[196:197]
    v_pk_fma_f32 v[198:199], v[156:157], v[180:181], v[198:199]
    v_pk_fma_f32 v[200:201], v[158:159], v[180:181], v[200:201]
    v_pk_fma_f32 v[186:187], v[146:147], v[178:179], v[186:187]
    v_pk_fma_f32 v[188:189], v[148:149], v[178:179], v[188:189]
    v_pk_fma_f32 v[190:191], v[150:151], v[178:179], v[190:191]
    v_pk_fma_f32 v[192:193], v[152:153], v[178:179], v[192:193]
    v_pk_fma_f32 v[194:195], v[154:155], v[178:179], v[194:195]
    v_pk_fma_f32 v[196:197], v[156:157], v[178:179], v[196:197]
    v_pk_fma_f32 v[198:199], v[158:159], v[178:179], v[198:199]
    v_pk_fma_f32 v[200:201], v[160:161], v[178:179], v[200:201]
    v_lshlrev_b32 v162, 16, v93
    v_and_b32 v163, 0xffff0000, v93
    v_lshlrev_b32 v164, 16, v97
    v_and_b32 v165, 0xffff0000, v97
    v_lshlrev_b32 v166, 16, v101
    v_and_b32 v167, 0xffff0000, v101
    v_lshlrev_b32 v168, 16, v105
    v_and_b32 v169, 0xffff0000, v105
    v_lshlrev_b32 v170, 16, v109
    v_and_b32 v171, 0xffff0000, v109
    v_lshlrev_b32 v172, 16, v113
    v_and_b32 v173, 0xffff0000, v113
    v_lshlrev_b32 v174, 16, v117
    v_and_b32 v175, 0xffff0000, v117
    v_lshlrev_b32 v176, 16, v121
    v_and_b32 v177, 0xffff0000, v121
    v_pk_mul_f32 v[186:187], v[186:187], v[162:163]
    v_pk_mul_f32 v[188:189], v[188:189], v[164:165]
    v_pk_mul_f32 v[190:191], v[190:191], v[166:167]
    v_pk_mul_f32 v[192:193], v[192:193], v[168:169]
    v_pk_mul_f32 v[194:195], v[194:195], v[170:171]
    v_pk_mul_f32 v[196:197], v[196:197], v[172:173]
    v_pk_mul_f32 v[198:199], v[198:199], v[174:175]
    v_pk_mul_f32 v[200:201], v[200:201], v[176:177]
    v_cvt_pk_bf16_f32 v212, v200, v198
    v_cvt_pk_bf16_f32 v213, v196, v194
    v_cvt_pk_bf16_f32 v214, v192, v190
    v_cvt_pk_bf16_f32 v215, v188, v186
    ds_write_b128 v1, v[212:215] offset:256
    v_cvt_pk_bf16_f32 v216, v201, v199
    v_cvt_pk_bf16_f32 v217, v197, v195
    v_cvt_pk_bf16_f32 v218, v193, v191
    v_cvt_pk_bf16_f32 v219, v189, v187
    ds_write_b128 v1, v[216:219] offset:384
    s_waitcnt lgkmcnt(0)
    v_mov_b32 v4, 1
    s_mov_b64 exec, 1
    ds_add_u32 v14, v4 offset:1200
    s_mov_b64 exec, -1
    v_lshlrev_b32 v140, 16, v50
    v_and_b32 v141, 0xffff0000, v50
    v_lshlrev_b32 v142, 16, v54
    v_and_b32 v143, 0xffff0000, v54
    v_lshlrev_b32 v144, 16, v58
    v_and_b32 v145, 0xffff0000, v58
    v_lshlrev_b32 v146, 16, v62
    v_and_b32 v147, 0xffff0000, v62
    v_lshlrev_b32 v148, 16, v66
    v_and_b32 v149, 0xffff0000, v66
    v_lshlrev_b32 v150, 16, v70
    v_and_b32 v151, 0xffff0000, v70
    v_lshlrev_b32 v152, 16, v74
    v_and_b32 v153, 0xffff0000, v74
    v_lshlrev_b32 v154, 16, v78
    v_and_b32 v155, 0xffff0000, v78
    v_lshlrev_b32 v156, 16, v82
    v_and_b32 v157, 0xffff0000, v82
    v_lshlrev_b32 v158, 16, v86
    v_and_b32 v159, 0xffff0000, v86
    v_lshlrev_b32 v160, 16, v90
    v_and_b32 v161, 0xffff0000, v90
    s_mov_b32 s72, 800000
SB_38:
    ds_read_b32 v4, v14 offset:1200
    s_sub_u32 s72, s72, 1
    s_waitcnt lgkmcnt(0)
    v_readfirstlane_b32 s60, v4
    s_cmp_eq_u32 s72, 0
    s_cbranch_scc1 SB_38_D
    s_cmp_lt_u32 s60, 8
    s_cbranch_scc1 SB_38
SB_38_D:
    ds_read_b128 v[220:223], v6 offset:256
    ds_read_b128 v[224:227], v6 offset:384
    v_lshlrev_b32 v178, 16, v132
    v_and_b32 v180, 0xffff0000, v132
    v_lshlrev_b32 v182, 16, v133
    v_and_b32 v184, 0xffff0000, v133
    v_lshlrev_b32 v179, 16, v134
    v_and_b32 v181, 0xffff0000, v134
    v_lshlrev_b32 v183, 16, v135
    v_and_b32 v185, 0xffff0000, v135
    v_pk_mul_f32 v[186:187], v[140:141], v[184:185]
    v_pk_mul_f32 v[188:189], v[142:143], v[184:185]
    v_pk_mul_f32 v[190:191], v[144:145], v[184:185]
    v_pk_mul_f32 v[192:193], v[146:147], v[184:185]
    v_pk_mul_f32 v[194:195], v[148:149], v[184:185]
    v_pk_mul_f32 v[196:197], v[150:151], v[184:185]
    v_pk_mul_f32 v[198:199], v[152:153], v[184:185]
    v_pk_mul_f32 v[200:201], v[154:155], v[184:185]
    s_waitcnt lgkmcnt(1)
    buffer_store_dwordx4 v[220:223], v7, s[40:43], s66 offen sc1
    s_add_u32 s66, s66, 4096
    s_waitcnt lgkmcnt(0)
    buffer_store_dwordx4 v[224:227], v7, s[40:43], s66 offen sc1
    s_add_u32 s66, s66, 4096
    v_pk_fma_f32 v[186:187], v[142:143], v[182:183], v[186:187]
    v_pk_fma_f32 v[188:189], v[144:145], v[182:183], v[188:189]
    v_pk_fma_f32 v[190:191], v[146:147], v[182:183], v[190:191]
    v_pk_fma_f32 v[192:193], v[148:149], v[182:183], v[192:193]
    v_pk_fma_f32 v[194:195], v[150:151], v[182:183], v[194:195]
    v_pk_fma_f32 v[196:197], v[152:153], v[182:183], v[196:197]
    v_pk_fma_f32 v[198:199], v[154:155], v[182:183], v[198:199]
    v_pk_fma_f32 v[200:201], v[156:157], v[182:183], v[200:201]
    v_pk_fma_f32 v[186:187], v[144:145], v[180:181], v[186:187]
    v_pk_fma_f32 v[188:189], v[146:147], v[180:181], v[188:189]
    v_pk_fma_f32 v[190:191], v[148:149], v[180:181], v[190:191]
    v_pk_fma_f32 v[192:193], v[150:151], v[180:181], v[192:193]
    v_pk_fma_f32 v[194:195], v[152:153], v[180:181], v[194:195]
    v_pk_fma_f32 v[196:197], v[154:155], v[180:181], v[196:197]
    v_pk_fma_f32 v[198:199], v[156:157], v[180:181], v[198:199]
    v_pk_fma_f32 v[200:201], v[158:159], v[180:181], v[200:201]
    v_pk_fma_f32 v[186:187], v[146:147], v[178:179], v[186:187]
    v_pk_fma_f32 v[188:189], v[148:149], v[178:179], v[188:189]
    v_pk_fma_f32 v[190:191], v[150:151], v[178:179], v[190:191]
    v_pk_fma_f32 v[192:193], v[152:153], v[178:179], v[192:193]
    v_pk_fma_f32 v[194:195], v[154:155], v[178:179], v[194:195]
    v_pk_fma_f32 v[196:197], v[156:157], v[178:179], v[196:197]
    v_pk_fma_f32 v[198:199], v[158:159], v[178:179], v[198:199]
    v_pk_fma_f32 v[200:201], v[160:161], v[178:179], v[200:201]
    v_lshlrev_b32 v162, 16, v94
    v_and_b32 v163, 0xffff0000, v94
    v_lshlrev_b32 v164, 16, v98
    v_and_b32 v165, 0xffff0000, v98
    v_lshlrev_b32 v166, 16, v102
    v_and_b32 v167, 0xffff0000, v102
    v_lshlrev_b32 v168, 16, v106
    v_and_b32 v169, 0xffff0000, v106
    v_lshlrev_b32 v170, 16, v110
    v_and_b32 v171, 0xffff0000, v110
    v_lshlrev_b32 v172, 16, v114
    v_and_b32 v173, 0xffff0000, v114
    v_lshlrev_b32 v174, 16, v118
    v_and_b32 v175, 0xffff0000, v118
    v_lshlrev_b32 v176, 16, v122
    v_and_b32 v177, 0xffff0000, v122
    v_pk_mul_f32 v[186:187], v[186:187], v[162:163]
    v_pk_mul_f32 v[188:189], v[188:189], v[164:165]
    v_pk_mul_f32 v[190:191], v[190:191], v[166:167]
    v_pk_mul_f32 v[192:193], v[192:193], v[168:169]
    v_pk_mul_f32 v[194:195], v[194:195], v[170:171]
    v_pk_mul_f32 v[196:197], v[196:197], v[172:173]
    v_pk_mul_f32 v[198:199], v[198:199], v[174:175]
    v_pk_mul_f32 v[200:201], v[200:201], v[176:177]
    v_cvt_pk_bf16_f32 v204, v200, v198
    v_cvt_pk_bf16_f32 v205, v196, v194
    v_cvt_pk_bf16_f32 v206, v192, v190
    v_cvt_pk_bf16_f32 v207, v188, v186
    ds_write_b128 v1, v[204:207] offset:512
    v_cvt_pk_bf16_f32 v208, v201, v199
    v_cvt_pk_bf16_f32 v209, v197, v195
    v_cvt_pk_bf16_f32 v210, v193, v191
    v_cvt_pk_bf16_f32 v211, v189, v187
    ds_write_b128 v1, v[208:211] offset:640
    s_waitcnt lgkmcnt(0)
    v_mov_b32 v4, 1
    s_mov_b64 exec, 1
    ds_add_u32 v14, v4 offset:1200
    s_mov_b64 exec, -1
    s_waitcnt vmcnt(4)
    v_readfirstlane_b32 s70, v248
    v_readfirstlane_b32 s71, v249
    s_nop 0
    s_cmp_lg_u32 s71, 0
    s_cbranch_scc1 L_SPN
    s_mov_b32 s72, 100000
    v_mov_b32 v250, 0
NON_39:
    buffer_load_dwordx2 v[248:249], v250, s[56:59], 0 offen sc1
    s_waitcnt vmcnt(0)
    v_readfirstlane_b32 s70, v248
    v_readfirstlane_b32 s71, v249
    s_nop 0
    s_cmp_lg_u32 s71, 0
    s_cbranch_scc1 NOND_40
    s_sleep 4
    s_sub_u32 s72, s72, 1
    s_cmp_lg_u32 s72, 0
    s_cbranch_scc1 NON_39
NOND_40:
    s_xor_b32 s71, s70, 1540483477
L_SPN:
    s_xor_b32 s71, s70, 1540483477
    s_cmp_lg_u32 s62, 0
    s_cbranch_scc1 L_SPNS
    v_mfma_f32_16x16x32_bf16 v[228:231], v[16:19], v[16:19], 0
    v_mfma_f32_16x16x32_bf16 v[232:235], v[16:19], v[244:247], 0
    v_mfma_f32_16x16x32_bf16 v[228:231], v[20:23], v[20:23], v[228:231]
    v_mfma_f32_16x16x32_bf16 v[232:235], v[20:23], v[244:247], v[232:235]
    v_lshrrev_b32 v236, 4, v0
    v_mul_u32_u24 v236, 20, v236
    v_sub_u32 v236, v0, v236
    v_mov_b32 v237, 0
    v_cmp_eq_u32 vcc, 0, v236
    s_nop 1
    v_cndmask_b32 v237, v237, v228, vcc
    v_cmp_eq_u32 vcc, 1, v236
    s_nop 1
    v_cndmask_b32 v237, v237, v229, vcc
    v_cmp_eq_u32 vcc, 2, v236
    s_nop 1
    v_cndmask_b32 v237, v237, v230, vcc
    v_cmp_eq_u32 vcc, 3, v236
    s_nop 1
    v_cndmask_b32 v237, v237, v231, vcc
    v_add_f32 v232, v232, v233
    v_add_f32 v234, v234, v235
    v_add_f32_dpp v237, v237, v237 quad_perm:[1,0,3,2] row_mask:0xf bank_mask:0xf
    s_nop 1
    v_add_f32_dpp v237, v237, v237 quad_perm:[2,3,0,1] row_mask:0xf bank_mask:0xf
    s_nop 1
    v_add_f32_dpp v237, v237, v237 row_half_mirror row_mask:0xf bank_mask:0xf
    s_nop 1
    v_add_f32_dpp v237, v237, v237 row_mirror row_mask:0xf bank_mask:0xf
    v_add_f32 v232, v232, v234
    v_mov_b32 v228, v237
    v_mov_b32 v233, v232
    s_nop 0
    v_permlane16_swap_b32 v228, v237
    v_permlane16_swap_b32 v232, v233
    v_add_f32 v228, v228, v237
    v_add_f32 v232, v232, v233
    v_mul_f32 v232, 0x3b000000, v232
    v_mul_f32 v229, v232, v232
    v_mul_f32 v228, 0x3b000000, v228
    v_sub_f32 v228, v228, v229
    v_max_f32 v228, 0, v228
    v_cvt_pk_bf16_f32 v228, v228, v228
    v_lshlrev_b32 v228, 16, v228
    v_add_f32 v228, 0x3727c5ac, v228
    v_cvt_pk_bf16_f32 v228, v228, v228
    v_lshlrev_b32 v228, 16, v228
    v_sqrt_f32 v228, v228
    v_lshrrev_b32 v229, 2, v0
    v_cvt_pk_bf16_f32 v230, v232, v228
    v_mov_b32 v231, s70
    s_lshl_b32 s60, s31, 5
    s_add_u32 s60, s60, s32
    s_lshl_b32 s60, s60, 2
    s_and_b32 s61, s30, 3
    s_add_u32 s60, s60, s61
    s_lshl_b32 s60, s60, 4
    s_add_u32 s60, s60, 65536
    s_mov_b32 exec_lo, 1
    s_mov_b32 exec_hi, 1
    buffer_store_dwordx2 v[230:231], v229, s[40:43], s60 offen sc1
    s_mov_b64 exec, -1
L_SPNS:
    v_lshlrev_b32 v140, 16, v51
    v_and_b32 v141, 0xffff0000, v51
    v_lshlrev_b32 v142, 16, v55
    v_and_b32 v143, 0xffff0000, v55
    v_lshlrev_b32 v144, 16, v59
    v_and_b32 v145, 0xffff0000, v59
    v_lshlrev_b32 v146, 16, v63
    v_and_b32 v147, 0xffff0000, v63
    v_lshlrev_b32 v148, 16, v67
    v_and_b32 v149, 0xffff0000, v67
    v_lshlrev_b32 v150, 16, v71
    v_and_b32 v151, 0xffff0000, v71
    v_lshlrev_b32 v152, 16, v75
    v_and_b32 v153, 0xffff0000, v75
    v_lshlrev_b32 v154, 16, v79
    v_and_b32 v155, 0xffff0000, v79
    v_lshlrev_b32 v156, 16, v83
    v_and_b32 v157, 0xffff0000, v83
    v_lshlrev_b32 v158, 16, v87
    v_and_b32 v159, 0xffff0000, v87
    v_lshlrev_b32 v160, 16, v91
    v_and_b32 v161, 0xffff0000, v91
    s_mov_b32 s72, 800000
SB_41:
    ds_read_b32 v4, v14 offset:1200
    s_sub_u32 s72, s72, 1
    s_waitcnt lgkmcnt(0)
    v_readfirstlane_b32 s60, v4
    s_cmp_eq_u32 s72, 0
    s_cbranch_scc1 SB_41_D
    s_cmp_lt_u32 s60, 12
    s_cbranch_scc1 SB_41
SB_41_D:
    ds_read_b128 v[220:223], v6 offset:512
    ds_read_b128 v[224:227], v6 offset:640
    v_lshlrev_b32 v178, 16, v136
    v_and_b32 v180, 0xffff0000, v136
    v_lshlrev_b32 v182, 16, v137
    v_and_b32 v184, 0xffff0000, v137
    v_lshlrev_b32 v179, 16, v138
    v_and_b32 v181, 0xffff0000, v138
    v_lshlrev_b32 v183, 16, v139
    v_and_b32 v185, 0xffff0000, v139
    v_pk_mul_f32 v[186:187], v[140:141], v[184:185]
    v_pk_mul_f32 v[188:189], v[142:143], v[184:185]
    v_pk_mul_f32 v[190:191], v[144:145], v[184:185]
    v_pk_mul_f32 v[192:193], v[146:147], v[184:185]
    v_pk_mul_f32 v[194:195], v[148:149], v[184:185]
    v_pk_mul_f32 v[196:197], v[150:151], v[184:185]
    v_pk_mul_f32 v[198:199], v[152:153], v[184:185]
    v_pk_mul_f32 v[200:201], v[154:155], v[184:185]
    s_waitcnt lgkmcnt(1)
    buffer_store_dwordx4 v[220:223], v7, s[40:43], s66 offen sc1
    s_add_u32 s66, s66, 4096
    s_waitcnt lgkmcnt(0)
    buffer_store_dwordx4 v[224:227], v7, s[40:43], s66 offen sc1
    s_add_u32 s66, s66, 4096
    v_pk_fma_f32 v[186:187], v[142:143], v[182:183], v[186:187]
    v_pk_fma_f32 v[188:189], v[144:145], v[182:183], v[188:189]
    v_pk_fma_f32 v[190:191], v[146:147], v[182:183], v[190:191]
    v_pk_fma_f32 v[192:193], v[148:149], v[182:183], v[192:193]
    v_pk_fma_f32 v[194:195], v[150:151], v[182:183], v[194:195]
    v_pk_fma_f32 v[196:197], v[152:153], v[182:183], v[196:197]
    v_pk_fma_f32 v[198:199], v[154:155], v[182:183], v[198:199]
    v_pk_fma_f32 v[200:201], v[156:157], v[182:183], v[200:201]
    v_pk_fma_f32 v[186:187], v[144:145], v[180:181], v[186:187]
    v_pk_fma_f32 v[188:189], v[146:147], v[180:181], v[188:189]
    v_pk_fma_f32 v[190:191], v[148:149], v[180:181], v[190:191]
    v_pk_fma_f32 v[192:193], v[150:151], v[180:181], v[192:193]
    v_pk_fma_f32 v[194:195], v[152:153], v[180:181], v[194:195]
    v_pk_fma_f32 v[196:197], v[154:155], v[180:181], v[196:197]
    v_pk_fma_f32 v[198:199], v[156:157], v[180:181], v[198:199]
    v_pk_fma_f32 v[200:201], v[158:159], v[180:181], v[200:201]
    v_pk_fma_f32 v[186:187], v[146:147], v[178:179], v[186:187]
    v_pk_fma_f32 v[188:189], v[148:149], v[178:179], v[188:189]
    v_pk_fma_f32 v[190:191], v[150:151], v[178:179], v[190:191]
    v_pk_fma_f32 v[192:193], v[152:153], v[178:179], v[192:193]
    v_pk_fma_f32 v[194:195], v[154:155], v[178:179], v[194:195]
    v_pk_fma_f32 v[196:197], v[156:157], v[178:179], v[196:197]
    v_pk_fma_f32 v[198:199], v[158:159], v[178:179], v[198:199]
    v_pk_fma_f32 v[200:201], v[160:161], v[178:179], v[200:201]
    v_lshlrev_b32 v162, 16, v95
    v_and_b32 v163, 0xffff0000, v95
    v_lshlrev_b32 v164, 16, v99
    v_and_b32 v165, 0xffff0000, v99
    v_lshlrev_b32 v166, 16, v103
    v_and_b32 v167, 0xffff0000, v103
    v_lshlrev_b32 v168, 16, v107
    v_and_b32 v169, 0xffff0000, v107
    v_lshlrev_b32 v170, 16, v111
    v_and_b32 v171, 0xffff0000, v111
    v_lshlrev_b32 v172, 16, v115
    v_and_b32 v173, 0xffff0000, v115
    v_lshlrev_b32 v174, 16, v119
    v_and_b32 v175, 0xffff0000, v119
    v_lshlrev_b32 v176, 16, v123
    v_and_b32 v177, 0xffff0000, v123
    v_pk_mul_f32 v[186:187], v[186:187], v[162:163]
    v_pk_mul_f32 v[188:189], v[188:189], v[164:165]
    v_pk_mul_f32 v[190:191], v[190:191], v[166:167]
    v_pk_mul_f32 v[192:193], v[192:193], v[168:169]
    v_pk_mul_f32 v[194:195], v[194:195], v[170:171]
    v_pk_mul_f32 v[196:197], v[196:197], v[172:173]
    v_pk_mul_f32 v[198:199], v[198:199], v[174:175]
    v_pk_mul_f32 v[200:201], v[200:201], v[176:177]
    v_cvt_pk_bf16_f32 v212, v200, v198
    v_cvt_pk_bf16_f32 v213, v196, v194
    v_cvt_pk_bf16_f32 v214, v192, v190
    v_cvt_pk_bf16_f32 v215, v188, v186
    ds_write_b128 v1, v[212:215] offset:768
    v_cvt_pk_bf16_f32 v216, v201, v199
    v_cvt_pk_bf16_f32 v217, v197, v195
    v_cvt_pk_bf16_f32 v218, v193, v191
    v_cvt_pk_bf16_f32 v219, v189, v187
    ds_write_b128 v1, v[216:219] offset:896
    s_waitcnt lgkmcnt(0)
    v_mov_b32 v4, 1
    s_mov_b64 exec, 1
    ds_add_u32 v14, v4 offset:1200
    s_mov_b64 exec, -1
    s_mov_b32 s72, 800000
SB_42:
    ds_read_b32 v4, v14 offset:1200
    s_sub_u32 s72, s72, 1
    s_waitcnt lgkmcnt(0)
    v_readfirstlane_b32 s60, v4
    s_cmp_eq_u32 s72, 0
    s_cbranch_scc1 SB_42_D
    s_cmp_lt_u32 s60, 16
    s_cbranch_scc1 SB_42
SB_42_D:
    ds_read_b128 v[220:223], v6 offset:768
    ds_read_b128 v[224:227], v6 offset:896
    s_waitcnt lgkmcnt(1)
    buffer_store_dwordx4 v[220:223], v7, s[40:43], s66 offen sc1
    s_add_u32 s66, s66, 4096
    s_waitcnt lgkmcnt(0)
    buffer_store_dwordx4 v[224:227], v7, s[40:43], s66 offen sc1
    s_add_u32 s66, s66, 4096
    v_mov_b32 v4, 1
    s_mov_b64 exec, 1
    ds_add_u32 v250, v4 offset:1208
    s_mov_b64 exec, -1
    v_mov_b32 v68, 0
    s_lshl_b32 s60, s30, 5
    s_add_u32 s60, s60, s3
    s_lshl_b32 s60, s60, 7
    s_add_u32 s60, s60, 393216
    v_mov_b32 v4, s70
    v_mov_b32 v5, s71
    v_lshlrev_b32 v6, 15, v0
    s_waitcnt vmcnt(0)
    s_mov_b64 exec, 1
    buffer_store_dwordx2 v[4:5], v6, s[40:43], s60 offen sc1
    s_mov_b64 exec, -1
    v_mov_b32 v69, 1
    s_mov_b64 exec, 1
    ds_add_u32 v68, v69 offset:1212
    s_mov_b64 exec, -1
    s_cmp_ge_u32 s30, 4
    s_cbranch_scc1 L_SPH
    v_and_b32 v74, 15, v0
    v_lshlrev_b32 v74, 7, v74
    s_lshr_b32 s75, s2, 5
    s_lshl_b32 s75, s75, 12
    s_and_b32 s60, s30, 1
    s_lshl_b32 s60, s60, 11
    s_sub_u32 s75, s75, s60
    s_add_u32 s75, s75, 395264
    s_branch L_KVPOLL
L_SPH:
    s_mov_b32 s72, 800000
SB_43:
    ds_read_b32 v69, v68 offset:1208
    s_sub_u32 s72, s72, 1
    s_waitcnt lgkmcnt(0)
    v_readfirstlane_b32 s60, v69
    s_cmp_eq_u32 s72, 0
    s_cbranch_scc1 SB_43_D
    s_cmp_lt_u32 s60, 8
    s_cbranch_scc1 SB_43
SB_43_D:
    s_mov_b32 s52, s22
    s_mov_b32 s53, s23
    s_mov_b32 s54, 1835008
    s_mov_b32 s55, 0x20000
    v_lshrrev_b32 v1, 3, v0
    v_and_b32 v2, 6, v1
    v_and_b32 v3, 7, v0
    v_xor_b32 v2, v2, v3
    v_lshlrev_b32 v2, 4, v2
    v_lshl_add_u32 v10, v1, 10, v2
    s_mul_i32 s78, s77, 458752
    s_lshl_b32 s60, s38, 7
    s_add_u32 s78, s78, s60
    s_mul_i32 s79, s77, 12288
    s_mul_i32 s74, s31, 7
    s_lshr_b32 s74, s74, 3
    s_lshl_b32 s74, s74, 2
    v_lshrrev_b32 v2, 2, v0
    v_and_b32 v3, 6, v2
    v_bfe_u32 v4, v0, 1, 1
    v_add_u32 v3, v3, v4
    v_lshlrev_b32 v3, 4, v3
    v_and_b32 v4, 1, v0
    v_lshl_add_u32 v3, v4, 3, v3
    v_lshl_add_u32 v3, v2, 7, v3
    s_add_u32 s60, s79, 65536
    v_add_u32 v11, s60, v3
    v_xor_b32 v12, 32, v11
    v_lshlrev_b32 v66, 7, v0
    s_lshr_b32 s73, s32, 3
    s_mul_i32 s73, s73, 0
    s_add_u32 s73, s73, s74
    s_sub_u32 s60, s73, 28
    s_cmp_ge_u32 s73, 28
    s_cselect_b32 s73, s60, s73
    s_add_u32 s60, s74, 0
    s_lshl_b32 s60, s60, 14
    s_add_u32 s60, s60, s78
    s_add_u32 m0, s79, 114688
    s_add_u32 s61, s60, 8192
    buffer_load_dwordx4 v10, s[52:55], s60 offen lds
    s_add_u32 m0, s79, 115712
    s_nop 0
    buffer_load_dwordx4 v10, s[52:55], s61 offen lds
    s_add_u32 s60, s74, 1
    s_lshl_b32 s60, s60, 14
    s_add_u32 s60, s60, s78
    s_add_u32 m0, s79, 116736
    s_add_u32 s61, s60, 8192
    buffer_load_dwordx4 v10, s[52:55], s60 offen lds
    s_add_u32 m0, s79, 117760
    s_nop 0
    buffer_load_dwordx4 v10, s[52:55], s61 offen lds
    s_mov_b32 s72, 800000
SB_44:
    s_sleep 4
    ds_read_b32 v69, v68 offset:1152
    s_sub_u32 s72, s72, 1
    s_waitcnt lgkmcnt(0)
    v_readfirstlane_b32 s60, v69
    s_cmp_eq_u32 s72, 0
    s_cbranch_scc1 SB_44_D
    s_cmp_lt_u32 s60, 4
    s_cbranch_scc1 SB_44
SB_44_D:
    s_add_u32 s60, s73, 2
    s_lshl_b32 s60, s60, 14
    s_add_u32 s60, s60, s78
    s_add_u32 m0, s79, 118784
    s_add_u32 s61, s60, 8192
    buffer_load_dwordx4 v10, s[52:55], s60 offen lds
    s_add_u32 m0, s79, 119808
    s_nop 0
    buffer_load_dwordx4 v10, s[52:55], s61 offen lds
    s_add_u32 s60, s73, 3
    s_lshl_b32 s60, s60, 14
    s_add_u32 s60, s60, s78
    s_add_u32 m0, s79, 120832
    s_add_u32 s61, s60, 8192
    buffer_load_dwordx4 v10, s[52:55], s60 offen lds
    s_add_u32 m0, s79, 121856
    s_nop 0
    buffer_load_dwordx4 v10, s[52:55], s61 offen lds
    v_xor_b32 v13, 64, v11
    v_xor_b32 v14, 96, v11
    s_add_u32 s60, s74, 4
    s_sub_u32 s61, s60, 28
    s_cmp_ge_u32 s60, 28
    s_cselect_b32 s60, s61, s60
    s_lshl_b32 s60, s60, 14
    s_add_u32 s60, s60, s78
    s_add_u32 m0, s79, 122880
    s_add_u32 s61, s60, 8192
    buffer_load_dwordx4 v10, s[52:55], s60 offen lds
    s_add_u32 m0, s79, 123904
    s_nop 0
    buffer_load_dwordx4 v10, s[52:55], s61 offen lds
    s_add_u32 s60, s74, 5
    s_sub_u32 s61, s60, 28
    s_cmp_ge_u32 s60, 28
    s_cselect_b32 s60, s61, s60
    s_lshl_b32 s60, s60, 14
    s_add_u32 s60, s60, s78
    s_add_u32 m0, s79, 124928
    s_add_u32 s61, s60, 8192
    buffer_load_dwordx4 v10, s[52:55], s60 offen lds
    s_add_u32 m0, s79, 125952
    s_nop 0
    buffer_load_dwordx4 v10, s[52:55], s61 offen lds
    s_waitcnt vmcnt(10)
    ds_read_b64_tr_b16 v[80:81], v11 offset:49152
    ds_read_b64_tr_b16 v[84:85], v12 offset:49152
    ds_read_b64_tr_b16 v[88:89], v13 offset:49152
    ds_read_b64_tr_b16 v[92:93], v14 offset:49152
    s_add_u32 s60, s74, 8
    s_sub_u32 s61, s60, 28
    s_cmp_ge_u32 s60, 28
    s_cselect_b32 s60, s61, s60
    s_lshl_b32 s60, s60, 14
    s_add_u32 s60, s60, s78
    s_add_u32 m0, s79, 65536
    s_add_u32 s61, s60, 8192
    buffer_load_dwordx4 v10, s[52:55], s60 offen lds
    s_add_u32 m0, s79, 66560
    s_nop 0
    buffer_load_dwordx4 v10, s[52:55], s61 offen lds
    s_waitcnt vmcnt(10)
    ds_read_b64_tr_b16 v[82:83], v11 offset:51200
    ds_read_b64_tr_b16 v[86:87], v12 offset:51200
    ds_read_b64_tr_b16 v[90:91], v13 offset:51200
    ds_read_b64_tr_b16 v[94:95], v14 offset:51200
    s_add_u32 s60, s74, 9
    s_sub_u32 s61, s60, 28
    s_cmp_ge_u32 s60, 28
    s_cselect_b32 s60, s61, s60
    s_lshl_b32 s60, s60, 14
    s_add_u32 s60, s60, s78
    s_add_u32 m0, s79, 67584
    s_add_u32 s61, s60, 8192
    buffer_load_dwordx4 v10, s[52:55], s60 offen lds
    s_add_u32 m0, s79, 68608
    s_nop 0
    buffer_load_dwordx4 v10, s[52:55], s61 offen lds
    s_waitcnt vmcnt(10)
    ds_read_b64_tr_b16 v[192:193], v11 offset:53248
    ds_read_b64_tr_b16 v[196:197], v12 offset:53248
    ds_read_b64_tr_b16 v[200:201], v13 offset:53248
    ds_read_b64_tr_b16 v[204:205], v14 offset:53248
    s_waitcnt lgkmcnt(4)
    s_add_u32 s60, s74, 12
    s_sub_u32 s61, s60, 28
    s_cmp_ge_u32 s60, 28
    s_cselect_b32 s60, s61, s60
    s_lshl_b32 s60, s60, 14
    s_add_u32 s60, s60, s78
    s_add_u32 m0, s79, 69632
    s_add_u32 s61, s60, 8192
    buffer_load_dwordx4 v10, s[52:55], s60 offen lds
    s_add_u32 m0, s79, 70656
    s_nop 0
    buffer_load_dwordx4 v10, s[52:55], s61 offen lds
    s_waitcnt vmcnt(10)
    ds_read_b64_tr_b16 v[194:195], v11 offset:55296
    ds_read_b64_tr_b16 v[198:199], v12 offset:55296
    ds_read_b64_tr_b16 v[202:203], v13 offset:55296
    ds_read_b64_tr_b16 v[206:207], v14 offset:55296
    s_add_u32 s60, s74, 13
    s_sub_u32 s61, s60, 28
    s_cmp_ge_u32 s60, 28
    s_cselect_b32 s60, s61, s60
    s_lshl_b32 s60, s60, 14
    s_add_u32 s60, s60, s78
    s_add_u32 m0, s79, 71680
    s_add_u32 s61, s60, 8192
    buffer_load_dwordx4 v10, s[52:55], s60 offen lds
    s_add_u32 m0, s79, 72704
    s_nop 0
    buffer_load_dwordx4 v10, s[52:55], s61 offen lds
    s_waitcnt vmcnt(10)
    ds_read_b64_tr_b16 v[96:97], v11 offset:57344
    ds_read_b64_tr_b16 v[100:101], v12 offset:57344
    ds_read_b64_tr_b16 v[104:105], v13 offset:57344
    ds_read_b64_tr_b16 v[108:109], v14 offset:57344
    s_add_u32 s60, s74, 16
    s_sub_u32 s61, s60, 28
    s_cmp_ge_u32 s60, 28
    s_cselect_b32 s60, s61, s60
    s_lshl_b32 s60, s60, 14
    s_add_u32 s60, s60, s78
    s_add_u32 m0, s79, 73728
    s_add_u32 s61, s60, 8192
    buffer_load_dwordx4 v10, s[52:55], s60 offen lds
    s_add_u32 m0, s79, 74752
    s_nop 0
    buffer_load_dwordx4 v10, s[52:55], s61 offen lds
    s_waitcnt vmcnt(10)
    ds_read_b64_tr_b16 v[98:99], v11 offset:59392
    ds_read_b64_tr_b16 v[102:103], v12 offset:59392
    ds_read_b64_tr_b16 v[106:107], v13 offset:59392
    ds_read_b64_tr_b16 v[110:111], v14 offset:59392
    s_waitcnt lgkmcnt(4)
    s_add_u32 s60, s74, 17
    s_sub_u32 s61, s60, 28
    s_cmp_ge_u32 s60, 28
    s_cselect_b32 s60, s61, s60
    s_lshl_b32 s60, s60, 14
    s_add_u32 s60, s60, s78
    s_add_u32 m0, s79, 75776
    s_add_u32 s61, s60, 8192
    buffer_load_dwordx4 v10, s[52:55], s60 offen lds
    s_add_u32 m0, s79, 76800
    s_nop 0
    buffer_load_dwordx4 v10, s[52:55], s61 offen lds
    s_waitcnt vmcnt(10)
    ds_read_b64_tr_b16 v[112:113], v11 offset:0
    ds_read_b64_tr_b16 v[116:117], v12 offset:0
    ds_read_b64_tr_b16 v[120:121], v13 offset:0
    ds_read_b64_tr_b16 v[124:125], v14 offset:0
    s_waitcnt lgkmcnt(0)
    s_add_u32 s60, s74, 20
    s_sub_u32 s61, s60, 28
    s_cmp_ge_u32 s60, 28
    s_cselect_b32 s60, s61, s60
    s_lshl_b32 s60, s60, 14
    s_add_u32 s60, s60, s78
    s_add_u32 m0, s79, 114688
    s_add_u32 s61, s60, 8192
    buffer_load_dwordx4 v10, s[52:55], s60 offen lds
    s_add_u32 m0, s79, 115712
    s_nop 0
    buffer_load_dwordx4 v10, s[52:55], s61 offen lds
    s_waitcnt vmcnt(10)
    ds_read_b64_tr_b16 v[114:115], v11 offset:2048
    ds_read_b64_tr_b16 v[118:119], v12 offset:2048
    ds_read_b64_tr_b16 v[122:123], v13 offset:2048
    ds_read_b64_tr_b16 v[126:127], v14 offset:2048
    s_waitcnt lgkmcnt(0)
    s_add_u32 s60, s74, 21
    s_sub_u32 s61, s60, 28
    s_cmp_ge_u32 s60, 28
    s_cselect_b32 s60, s61, s60
    s_lshl_b32 s60, s60, 14
    s_add_u32 s60, s60, s78
    s_add_u32 m0, s79, 116736
    s_add_u32 s61, s60, 8192
    buffer_load_dwordx4 v10, s[52:55], s60 offen lds
    s_add_u32 m0, s79, 117760
    s_nop 0
    buffer_load_dwordx4 v10, s[52:55], s61 offen lds
    s_waitcnt vmcnt(10)
    ds_read_b64_tr_b16 v[128:129], v11 offset:4096
    ds_read_b64_tr_b16 v[132:133], v12 offset:4096
    ds_read_b64_tr_b16 v[136:137], v13 offset:4096
    ds_read_b64_tr_b16 v[140:141], v14 offset:4096
    s_waitcnt lgkmcnt(4)
    s_waitcnt lgkmcnt(0)
    s_add_u32 s60, s74, 24
    s_sub_u32 s61, s60, 28
    s_cmp_ge_u32 s60, 28
    s_cselect_b32 s60, s61, s60
    s_lshl_b32 s60, s60, 14
    s_add_u32 s60, s60, s78
    s_add_u32 m0, s79, 118784
    s_add_u32 s61, s60, 8192
    buffer_load_dwordx4 v10, s[52:55], s60 offen lds
    s_add_u32 m0, s79, 119808
    s_nop 0
    buffer_load_dwordx4 v10, s[52:55], s61 offen lds
    s_waitcnt vmcnt(10)
    ds_read_b64_tr_b16 v[130:131], v11 offset:6144
    ds_read_b64_tr_b16 v[134:135], v12 offset:6144
    ds_read_b64_tr_b16 v[138:139], v13 offset:6144
    ds_read_b64_tr_b16 v[142:143], v14 offset:6144
    s_waitcnt lgkmcnt(0)
    s_add_u32 s60, s74, 25
    s_sub_u32 s61, s60, 28
    s_cmp_ge_u32 s60, 28
    s_cselect_b32 s60, s61, s60
    s_lshl_b32 s60, s60, 14
    s_add_u32 s60, s60, s78
    s_add_u32 m0, s79, 120832
    s_add_u32 s61, s60, 8192
    buffer_load_dwordx4 v10, s[52:55], s60 offen lds
    s_add_u32 m0, s79, 121856
    s_nop 0
    buffer_load_dwordx4 v10, s[52:55], s61 offen lds
    s_waitcnt vmcnt(10)
    ds_read_b64_tr_b16 v[144:145], v11 offset:8192
    ds_read_b64_tr_b16 v[148:149], v12 offset:8192
    ds_read_b64_tr_b16 v[152:153], v13 offset:8192
    ds_read_b64_tr_b16 v[156:157], v14 offset:8192
    s_waitcnt lgkmcnt(0)
    s_add_u32 s60, s73, 6
    s_sub_u32 s61, s60, 28
    s_cmp_ge_u32 s60, 28
    s_cselect_b32 s60, s61, s60
    s_lshl_b32 s60, s60, 14
    s_add_u32 s60, s60, s78
    s_add_u32 m0, s79, 122880
    s_add_u32 s61, s60, 8192
    buffer_load_dwordx4 v10, s[52:55], s60 offen lds
    s_add_u32 m0, s79, 123904
    s_nop 0
    buffer_load_dwordx4 v10, s[52:55], s61 offen lds
    s_waitcnt vmcnt(10)
    ds_read_b64_tr_b16 v[146:147], v11 offset:10240
    ds_read_b64_tr_b16 v[150:151], v12 offset:10240
    ds_read_b64_tr_b16 v[154:155], v13 offset:10240
    ds_read_b64_tr_b16 v[158:159], v14 offset:10240
    s_waitcnt lgkmcnt(4)
    s_waitcnt lgkmcnt(0)
    s_add_u32 s60, s73, 7
    s_sub_u32 s61, s60, 28
    s_cmp_ge_u32 s60, 28
    s_cselect_b32 s60, s61, s60
    s_lshl_b32 s60, s60, 14
    s_add_u32 s60, s60, s78
    s_add_u32 m0, s79, 124928
    s_add_u32 s61, s60, 8192
    buffer_load_dwordx4 v10, s[52:55], s60 offen lds
    s_add_u32 m0, s79, 125952
    s_nop 0
    buffer_load_dwordx4 v10, s[52:55], s61 offen lds
    s_waitcnt vmcnt(10)
    ds_read_b64_tr_b16 v[160:161], v11 offset:49152
    ds_read_b64_tr_b16 v[164:165], v12 offset:49152
    ds_read_b64_tr_b16 v[168:169], v13 offset:49152
    ds_read_b64_tr_b16 v[172:173], v14 offset:49152
    s_waitcnt lgkmcnt(0)
    s_add_u32 s60, s73, 10
    s_sub_u32 s61, s60, 28
    s_cmp_ge_u32 s60, 28
    s_cselect_b32 s60, s61, s60
    s_lshl_b32 s60, s60, 14
    s_add_u32 s60, s60, s78
    s_add_u32 m0, s79, 65536
    s_add_u32 s61, s60, 8192
    buffer_load_dwordx4 v10, s[52:55], s60 offen lds
    s_add_u32 m0, s79, 66560
    s_nop 0
    buffer_load_dwordx4 v10, s[52:55], s61 offen lds
    s_waitcnt vmcnt(10)
    ds_read_b64_tr_b16 v[162:163], v11 offset:51200
    ds_read_b64_tr_b16 v[166:167], v12 offset:51200
    ds_read_b64_tr_b16 v[170:171], v13 offset:51200
    ds_read_b64_tr_b16 v[174:175], v14 offset:51200
    s_waitcnt lgkmcnt(0)
    s_add_u32 s60, s73, 11
    s_sub_u32 s61, s60, 28
    s_cmp_ge_u32 s60, 28
    s_cselect_b32 s60, s61, s60
    s_lshl_b32 s60, s60, 14
    s_add_u32 s60, s60, s78
    s_add_u32 m0, s79, 67584
    s_add_u32 s61, s60, 8192
    buffer_load_dwordx4 v10, s[52:55], s60 offen lds
    s_add_u32 m0, s79, 68608
    s_nop 0
    buffer_load_dwordx4 v10, s[52:55], s61 offen lds
    s_waitcnt vmcnt(10)
    ds_read_b64_tr_b16 v[176:177], v11 offset:53248
    ds_read_b64_tr_b16 v[180:181], v12 offset:53248
    ds_read_b64_tr_b16 v[184:185], v13 offset:53248
    ds_read_b64_tr_b16 v[188:189], v14 offset:53248
    s_waitcnt lgkmcnt(4)
    s_waitcnt lgkmcnt(0)
    s_add_u32 s60, s73, 14
    s_sub_u32 s61, s60, 28
    s_cmp_ge_u32 s60, 28
    s_cselect_b32 s60, s61, s60
    s_lshl_b32 s60, s60, 14
    s_add_u32 s60, s60, s78
    s_add_u32 m0, s79, 69632
    s_add_u32 s61, s60, 8192
    buffer_load_dwordx4 v10, s[52:55], s60 offen lds
    s_add_u32 m0, s79, 70656
    s_nop 0
    buffer_load_dwordx4 v10, s[52:55], s61 offen lds
    s_waitcnt vmcnt(10)
    ds_read_b64_tr_b16 v[178:179], v11 offset:55296
    ds_read_b64_tr_b16 v[182:183], v12 offset:55296
    ds_read_b64_tr_b16 v[186:187], v13 offset:55296
    ds_read_b64_tr_b16 v[190:191], v14 offset:55296
    s_waitcnt lgkmcnt(0)
    s_add_u32 s60, s73, 15
    s_sub_u32 s61, s60, 28
    s_cmp_ge_u32 s60, 28
    s_cselect_b32 s60, s61, s60
    s_lshl_b32 s60, s60, 14
    s_add_u32 s60, s60, s78
    s_add_u32 m0, s79, 71680
    s_add_u32 s61, s60, 8192
    buffer_load_dwordx4 v10, s[52:55], s60 offen lds
    s_add_u32 m0, s79, 72704
    s_nop 0
    buffer_load_dwordx4 v10, s[52:55], s61 offen lds
    s_waitcnt vmcnt(10)
    s_waitcnt lgkmcnt(0)
    s_add_u32 s60, s73, 18
    s_sub_u32 s61, s60, 28
    s_cmp_ge_u32 s60, 28
    s_cselect_b32 s60, s61, s60
    s_lshl_b32 s60, s60, 14
    s_add_u32 s60, s60, s78
    s_add_u32 m0, s79, 73728
    s_add_u32 s61, s60, 8192
    buffer_load_dwordx4 v10, s[52:55], s60 offen lds
    s_add_u32 m0, s79, 74752
    s_nop 0
    buffer_load_dwordx4 v10, s[52:55], s61 offen lds
    s_waitcnt vmcnt(10)
    s_waitcnt lgkmcnt(0)
    s_add_u32 s60, s73, 19
    s_sub_u32 s61, s60, 28
    s_cmp_ge_u32 s60, 28
    s_cselect_b32 s60, s61, s60
    s_lshl_b32 s60, s60, 14
    s_add_u32 s60, s60, s78
    s_add_u32 m0, s79, 75776
    s_add_u32 s61, s60, 8192
    buffer_load_dwordx4 v10, s[52:55], s60 offen lds
    s_add_u32 m0, s79, 76800
    s_nop 0
    buffer_load_dwordx4 v10, s[52:55], s61 offen lds
    s_waitcnt vmcnt(10)
    s_waitcnt lgkmcnt(0)
    s_add_u32 s60, s73, 22
    s_sub_u32 s61, s60, 28
    s_cmp_ge_u32 s60, 28
    s_cselect_b32 s60, s61, s60
    s_lshl_b32 s60, s60, 14
    s_add_u32 s60, s60, s78
    s_add_u32 m0, s79, 114688
    s_add_u32 s61, s60, 8192
    buffer_load_dwordx4 v10, s[52:55], s60 offen lds
    s_add_u32 m0, s79, 115712
    s_nop 0
    buffer_load_dwordx4 v10, s[52:55], s61 offen lds
    s_waitcnt vmcnt(10)
    s_waitcnt lgkmcnt(0)
    s_add_u32 s60, s73, 23
    s_sub_u32 s61, s60, 28
    s_cmp_ge_u32 s60, 28
    s_cselect_b32 s60, s61, s60
    s_lshl_b32 s60, s60, 14
    s_add_u32 s60, s60, s78
    s_add_u32 m0, s79, 116736
    s_add_u32 s61, s60, 8192
    buffer_load_dwordx4 v10, s[52:55], s60 offen lds
    s_add_u32 m0, s79, 117760
    s_nop 0
    buffer_load_dwordx4 v10, s[52:55], s61 offen lds
    s_waitcnt vmcnt(10)
    s_waitcnt lgkmcnt(0)
    s_add_u32 s60, s73, 26
    s_sub_u32 s61, s60, 28
    s_cmp_ge_u32 s60, 28
    s_cselect_b32 s60, s61, s60
    s_lshl_b32 s60, s60, 14
    s_add_u32 s60, s60, s78
    s_add_u32 m0, s79, 118784
    s_add_u32 s61, s60, 8192
    buffer_load_dwordx4 v10, s[52:55], s60 offen lds
    s_add_u32 m0, s79, 119808
    s_nop 0
    buffer_load_dwordx4 v10, s[52:55], s61 offen lds
    s_waitcnt vmcnt(10)
    s_waitcnt lgkmcnt(0)
    s_add_u32 s60, s73, 27
    s_sub_u32 s61, s60, 28
    s_cmp_ge_u32 s60, 28
    s_cselect_b32 s60, s61, s60
    s_lshl_b32 s60, s60, 14
    s_add_u32 s60, s60, s78
    s_add_u32 m0, s79, 120832
    s_add_u32 s61, s60, 8192
    buffer_load_dwordx4 v10, s[52:55], s60 offen lds
    s_add_u32 m0, s79, 121856
    s_nop 0
    buffer_load_dwordx4 v10, s[52:55], s61 offen lds
    v_min_u32 v4, 6, v0
    v_lshlrev_b32 v4, 7, v4
    s_lshl_b32 s75, s37, 2
    s_add_u32 s75, s75, s77
    s_lshl_b32 s75, s75, 10
    s_add_u32 s75, s75, 655360
    v_mov_b32 v6, 0
    v_mov_b32 v7, 0
    s_branch L_G2
L_END:
    s_endpgm
.section .rodata,"a"
.p2align 6
.amdhsa_kernel parallel_sum__ssm_conv_h3__glu_gated_geglu__prompt_kernel
  .amdhsa_next_free_vgpr 256
  .amdhsa_next_free_sgpr 102
  .amdhsa_accum_offset 256
  .amdhsa_group_segment_fixed_size 0
  .amdhsa_kernarg_size 104
  .amdhsa_user_sgpr_count 2
  .amdhsa_user_sgpr_kernarg_segment_ptr 1
  .amdhsa_system_sgpr_workgroup_id_x 1
.end_amdhsa_kernel
```
